```python
import torch

def _softmax(x, axis=-1):
    return torch.softmax(x, dim=axis)
def _gelu(x):
    return torch.nn.functional.gelu(x, approximate="tanh")
def _silu(x):
    return torch.nn.functional.silu(x)
def _sigmoid(x):
    return torch.sigmoid(x)
def _layernorm(x, axis=-1, eps=1e-5):
    m = x.mean(dim=axis, keepdim=True)
    v = x.var(dim=axis, keepdim=True, unbiased=False)
    return (x - m) / torch.sqrt(v + eps)
def _scatter_add(tgt, idx, src, axis=0):
    return tgt.clone().index_add_(axis, idx, src)
def _segment_sum(src, seg, n):
    out = torch.zeros((n,) + src.shape[1:], dtype=src.dtype)
    return out.index_add_(0, seg, src)
def _pad(x, pw):
    flat = tuple(v for pair in reversed(pw) for v in pair)
    return torch.nn.functional.pad(x, flat)

kernel_name = 'gated_mix__mha_block__grouped_kv_mqa__prompt'

def setup_inputs():

    _w = (lambda a: (lambda t: t.to(torch.bfloat16) if t.is_floating_point() else t)(torch.as_tensor(a)))
    def _A_setup():
        B, S, D, H = 1, 2048, 640, 32
        return {
            "x": _w((lambda *s: torch.randn(*s, dtype=torch.bfloat16) * 0.1)(B, S, D)),
            "wqkv": _w((lambda *s: torch.randn(*s, dtype=torch.bfloat16) * 0.4)(D, 3 * D)),
            "wo": _w((lambda *s: torch.randn(*s, dtype=torch.bfloat16) * 0.2)(D, D)),
        }
    _A_in = _A_setup()

    def _B_setup():
        B, S, D, H = 1, 2048, 640, 32
        Dh = D // H
        return {
            "x": _w((lambda *s: torch.randn(*s, dtype=torch.bfloat16) * 0.1)(B, S, D)),
            "wq": _w((lambda *s: torch.randn(*s, dtype=torch.bfloat16) * 0.4)(D, H * Dh)),
            "wk": _w((lambda *s: torch.randn(*s, dtype=torch.bfloat16) * 0.4)(D, Dh)),
            "wv": _w((lambda *s: torch.randn(*s, dtype=torch.bfloat16) * 0.4)(D, Dh)),
            "wo": _w((lambda *s: torch.randn(*s, dtype=torch.bfloat16) * 0.4)(H * Dh, D)),
        }
    _B_in = _B_setup()

    return {
        "A_x": _A_in["x"],
        "A_wqkv": _A_in["wqkv"],
        "A_wo": _A_in["wo"],
        "B_x": _B_in["x"],
        "B_wq": _B_in["wq"],
        "B_wk": _B_in["wk"],
        "B_wv": _B_in["wv"],
        "B_wo": _B_in["wo"],
        "gate_w": _w((lambda *s: torch.randn(*s, dtype=torch.bfloat16) * 0.1)(640) * 16.0),
    }

def reference(A_x, A_wqkv, A_wo, B_x, B_wq, B_wk, B_wv, B_wo, gate_w):
    def _A_ref(x, wqkv, wo):
        B, S, D = x.shape
        H = 32
        Dh = D // H
        qkv = (lambda x, *d: x.permute(*d))((x @ wqkv).reshape(B, S, 3, H, Dh), 2, 0, 3, 1, 4)
        q, k, v = qkv[0], qkv[1], qkv[2]
        scores = torch.einsum("bhqd,bhkd->bhqk", q, k) * (Dh ** -0.5)
        p = _softmax(scores, axis=-1)
        o = torch.einsum("bhqk,bhkd->bhqd", p, v)
        return (lambda x, *d: x.permute(*d))(o, 0, 2, 1, 3).reshape(B, S, D) @ wo

    def _B_ref(x, wq, wk, wv, wo):
        B, S, D = x.shape
        H = 32
        Dh = D // H
        q = (lambda x, *d: x.permute(*d))((x @ wq).reshape(B, S, H, Dh), 0, 2, 1, 3)
        k = x @ wk
        v = x @ wv
        scores = torch.einsum("bhqd,bkd->bhqk", q, k) * (Dh ** -0.5)
        p = _softmax(scores, axis=-1)
        o = torch.einsum("bhqk,bkd->bhqd", p, v)
        return (lambda x, *d: x.permute(*d))(o, 0, 2, 1, 3).reshape(B, S, H * Dh) @ wo

    x = A_x
    g = _sigmoid((x * gate_w).sum(-1, keepdims=True))
    a = _A_ref(x, A_wqkv, A_wo)
    b = _B_ref(x, B_wq, B_wk, B_wv, B_wo)
    return g * a + (1 - g) * b
```

```asm
; @launch kernel=proj_kernel grid=(256,1,1) block=(896,1,1) lds=160000
; @launch kernel=attn_kernel grid=(256,1,1) block=(576,1,1) lds=163840
.amdgcn_target "amdgcn-amd-amdhsa--gfx950"
.text
.globl proj_kernel
.p2align 8
.type proj_kernel,@function
proj_kernel:
    s_cmp_ge_u32 s2, 256
    s_cbranch_scc1 L_proj_done
    s_load_dwordx4 s[4:7], s[0:1], 0
    s_load_dwordx2 s[8:9], s[0:1], 32
    s_load_dwordx4 s[12:15], s[0:1], 48
    s_load_dwordx2 s[10:11], s[0:1], 40
    s_load_dwordx2 s[16:17], s[0:1], 88
    s_load_dwordx2 s[18:19], s[0:1], 64
    v_lshrrev_b32 v124, 6, v0
    v_and_b32 v123, 63, v0
    v_readfirstlane_b32 s36, v124
    s_nop 3
    s_add_u32 s39, s36, 10
    s_add_u32 s40, s36, 4
    s_cmp_lt_u32 s36, 4
    s_cselect_b32 s39, s39, s40
    s_sub_u32 s40, s36, 6
    s_cmp_lt_u32 s36, 6
    s_cselect_b32 s36, s39, s40
    s_and_b32 s39, s2, 1
    s_lshl_b32 s37, s39, 3
    s_lshr_b32 s39, s2, 3
    s_and_b32 s39, s39, 7
    s_add_u32 s37, s37, s39
    s_lshr_b32 s39, s2, 6
    s_lshl_b32 s38, s39, 2
    s_bfe_u32 s39, s2, 0x20001
    s_add_u32 s38, s38, s39
    s_mov_b32 s23, 0x00020000
    s_mov_b32 s27, 0x00020000
    s_mov_b32 s31, 0x00020000
    s_mov_b32 s35, 0x00020000
    s_mov_b32 s22, 2621440
    s_mov_b32 s30, 22020096
    s_mov_b32 s34, 1280
    s_and_b32 s57, s36, 3
    s_cmp_lt_u32 s38, 12
    s_mov_b32 s42, 3840
    s_cselect_b32 s42, s42, 1280
    s_mov_b32 s26, 2457600
    s_cselect_b32 s26, s26, 819200
    s_cselect_b32 s39, 0, 12
    s_sub_u32 s39, s38, s39
    s_mul_i32 s44, s39, 320
    s_waitcnt lgkmcnt(0)
    s_mov_b32 s20, s4
    s_and_b32 s21, s5, 0xffff
    s_mov_b32 s28, s16
    s_and_b32 s29, s17, 0xffff
    s_mov_b32 s32, s18
    s_and_b32 s33, s19, 0xffff
    s_cmp_eq_u32 s36, 8
    s_cbranch_scc1 L_proj_extra
    s_cmp_lt_u32 s38, 12
    s_cselect_b32 s24, s6, s8
    s_cselect_b32 s40, s7, s9
    s_and_b32 s25, s40, 0xffff
    s_cmp_eq_u32 s36, 9
    s_cbranch_scc0 L_proj_main
    s_load_dwordx2 s[4:5], s[0:1], 16
    s_mov_b32 s76, s24
    s_mov_b32 s77, s25
    s_mov_b32 s78, s26
    s_mov_b32 s79, s27
    v_lshrrev_b32 v66, 1, v123
    v_mul_u32_u24 v66, 1280, v66
    v_and_b32 v68, 1, v123
    v_lshl_add_u32 v66, v68, 7, v66
    v_cmp_lt_u32 vcc, 9, v123
    v_lshlrev_b32 v67, 7, v123
    s_sub_u32 s86, s42, 1280
    v_mov_b32 v68, s86
    v_cndmask_b32 v68, 0, v68, vcc
    v_add_u32 v67, v67, v68
    s_lshr_b32 s87, s2, 3
    s_bfe_u32 s84, s2, 0x20001
    s_lshl_b32 s84, s84, 5
    s_add_u32 s84, s84, s87
    s_and_b32 s85, s2, 1
    s_lshl_b32 s86, s85, 7
    s_add_u32 s84, s84, s86
    s_mul_i32 s84, s84, 10240
    s_lshl_b32 s85, s85, 5
    s_add_u32 s85, s85, s87
    s_lshl_b32 s85, s85, 1
    s_mul_i32 s85, s85, s42
    s_and_b32 s86, s38, 3
    s_mul_i32 s86, s86, 320
    s_sub_u32 s86, s44, s86
    s_add_u32 s85, s85, s86
    v_mul_u32_u24 v68, 43, v123
    v_lshrrev_b32 v68, 7, v68
    v_mul_u32_u24 v67, 3, v68
    v_sub_u32 v67, v123, v67
    v_lshlrev_b32 v67, 7, v67
    v_mul_u32_u24 v68, s42, v68
    v_add_u32 v67, v67, v68
    s_lshl_b32 s85, s37, 3
    s_mul_i32 s85, s85, s42
    s_and_b32 s86, s44, 0xffffff80
    s_add_u32 s85, s85, s86
    s_lshl_b32 s86, s42, 7
    s_mov_b32 exec_hi, 0
    s_mov_b32 exec_lo, 0xffff
    buffer_load_dword v69, v66, s[20:23], s84 offen offset:0
    s_mov_b32 exec_lo, 0xffffff
    buffer_load_dword v69, v67, s[76:79], s85 offen
    s_mov_b64 exec, -1
    s_add_u32 s85, s85, s86
    s_mov_b32 exec_hi, 0
    s_mov_b32 exec_lo, 0xffff
    buffer_load_dword v69, v66, s[20:23], s84 offen offset:256
    s_mov_b32 exec_lo, 0xffffff
    buffer_load_dword v69, v67, s[76:79], s85 offen
    s_mov_b64 exec, -1
    s_add_u32 s85, s85, s86
    s_mul_i32 s39, s2, 1639
    s_lshr_b32 s39, s39, 16
    s_mul_i32 s40, s39, 40
    s_sub_u32 s40, s2, s40
    s_mul_i32 s52, s40, 6554
    s_lshr_b32 s52, s52, 16
    s_mul_i32 s53, s52, 10
    s_sub_u32 s53, s40, s53
    v_lshrrev_b32 v124, 4, v123
    v_and_b32 v125, 15, v123
    s_and_b32 s54, s52, 1
    s_mul_i32 s54, s54, 320
    s_cmp_lt_u32 s53, 8
    s_cbranch_scc0 L_proj_rp_tail
    s_mul_i32 s55, s53, 40
    s_add_u32 s54, s54, s55
    v_lshrrev_b32 v126, 1, v124
    v_mul_u32_u24 v126, 20, v126
    v_and_b32 v127, 1, v124
    v_lshl_add_u32 v126, v127, 2, v126
    v_add_u32 v127, 8, v126
    s_branch L_proj_rp_go
L_proj_rp_tail:
    s_sub_u32 s55, s53, 8
    s_mul_i32 s55, s55, 160
    s_add_u32 s54, s54, s55
    v_mul_u32_u24 v126, 40, v124
    v_add_u32 v126, 16, v126
    v_add_u32 v127, 20, v126
L_proj_rp_go:
    v_mul_u32_u24 v126, 1280, v126
    v_mul_u32_u24 v127, 1280, v127
    v_lshl_add_u32 v126, v125, 1, v126
    v_lshl_add_u32 v127, v125, 1, v127
    s_mul_i32 s54, s54, 1280
    s_mul_i32 s55, s39, 224
    s_add_u32 s54, s54, s55
    s_mul_i32 s55, s39, 7168
    s_mul_i32 s53, s40, 40960
    s_add_u32 s55, s55, s53
    s_add_u32 s55, s55, 19922944
    v_lshlrev_b32 v124, 4, v123
    s_waitcnt lgkmcnt(0)
    s_cmp_lt_u32 s52, 2
    s_cselect_b32 s24, s4, s14
    s_cselect_b32 s40, s5, s15
    s_and_b32 s25, s40, 0xffff
    s_mov_b32 s26, 819200
    s_mul_i32 s39, s39, 7
    s_sub_i32 s39, 40, s39
    s_barrier
    s_mov_b32 exec_hi, 0
    s_mov_b32 exec_lo, 0xffff
    buffer_load_dword v69, v66, s[20:23], s84 offen offset:512
    s_mov_b32 exec_lo, 0xffffff
    buffer_load_dword v69, v67, s[76:79], s85 offen
    s_mov_b64 exec, -1
    s_add_u32 s85, s85, s86
    s_barrier
    s_mov_b32 exec_hi, 0
    s_mov_b32 exec_lo, 0xffff
    buffer_load_dword v69, v66, s[20:23], s84 offen offset:768
    s_mov_b32 exec_lo, 0xffffff
    buffer_load_dword v69, v67, s[76:79], s85 offen
    s_mov_b64 exec, -1
    s_add_u32 s85, s85, s86
    s_barrier
    s_mov_b32 exec_hi, 0
    s_mov_b32 exec_lo, 0xffff
    buffer_load_dword v69, v66, s[20:23], s84 offen offset:1024
    s_mov_b32 exec_lo, 0xffffff
    buffer_load_dword v69, v67, s[76:79], s85 offen
    s_mov_b64 exec, -1
    s_add_u32 s85, s85, s86
    s_barrier
    s_barrier
    s_barrier
    s_barrier
    s_barrier
    s_barrier
    s_cmp_gt_i32 s39, 0
    s_cbranch_scc0 L_proj_rp_ld
    buffer_load_ushort v0, v126, s[24:27], s54 offen offset:0
    buffer_load_ushort v1, v126, s[24:27], s54 offen offset:1280
    buffer_load_ushort v2, v126, s[24:27], s54 offen offset:2560
    buffer_load_ushort v3, v126, s[24:27], s54 offen offset:3840
    buffer_load_ushort v4, v127, s[24:27], s54 offen offset:0
    buffer_load_ushort v5, v127, s[24:27], s54 offen offset:1280
    buffer_load_ushort v6, v127, s[24:27], s54 offen offset:2560
    buffer_load_ushort v7, v127, s[24:27], s54 offen offset:3840
    s_add_u32 s54, s54, 32
    s_cmp_gt_i32 s39, 1
    s_cbranch_scc0 L_proj_rp_ld
    buffer_load_ushort v8, v126, s[24:27], s54 offen offset:0
    buffer_load_ushort v9, v126, s[24:27], s54 offen offset:1280
    buffer_load_ushort v10, v126, s[24:27], s54 offen offset:2560
    buffer_load_ushort v11, v126, s[24:27], s54 offen offset:3840
    buffer_load_ushort v12, v127, s[24:27], s54 offen offset:0
    buffer_load_ushort v13, v127, s[24:27], s54 offen offset:1280
    buffer_load_ushort v14, v127, s[24:27], s54 offen offset:2560
    buffer_load_ushort v15, v127, s[24:27], s54 offen offset:3840
    s_add_u32 s54, s54, 32
    s_cmp_gt_i32 s39, 2
    s_cbranch_scc0 L_proj_rp_ld
    buffer_load_ushort v16, v126, s[24:27], s54 offen offset:0
    buffer_load_ushort v17, v126, s[24:27], s54 offen offset:1280
    buffer_load_ushort v18, v126, s[24:27], s54 offen offset:2560
    buffer_load_ushort v19, v126, s[24:27], s54 offen offset:3840
    buffer_load_ushort v20, v127, s[24:27], s54 offen offset:0
    buffer_load_ushort v21, v127, s[24:27], s54 offen offset:1280
    buffer_load_ushort v22, v127, s[24:27], s54 offen offset:2560
    buffer_load_ushort v23, v127, s[24:27], s54 offen offset:3840
    s_add_u32 s54, s54, 32
    s_cmp_gt_i32 s39, 3
    s_cbranch_scc0 L_proj_rp_ld
    buffer_load_ushort v24, v126, s[24:27], s54 offen offset:0
    buffer_load_ushort v25, v126, s[24:27], s54 offen offset:1280
    buffer_load_ushort v26, v126, s[24:27], s54 offen offset:2560
    buffer_load_ushort v27, v126, s[24:27], s54 offen offset:3840
    buffer_load_ushort v28, v127, s[24:27], s54 offen offset:0
    buffer_load_ushort v29, v127, s[24:27], s54 offen offset:1280
    buffer_load_ushort v30, v127, s[24:27], s54 offen offset:2560
    buffer_load_ushort v31, v127, s[24:27], s54 offen offset:3840
    s_add_u32 s54, s54, 32
    s_cmp_gt_i32 s39, 4
    s_cbranch_scc0 L_proj_rp_ld
    buffer_load_ushort v32, v126, s[24:27], s54 offen offset:0
    buffer_load_ushort v33, v126, s[24:27], s54 offen offset:1280
    buffer_load_ushort v34, v126, s[24:27], s54 offen offset:2560
    buffer_load_ushort v35, v126, s[24:27], s54 offen offset:3840
    buffer_load_ushort v36, v127, s[24:27], s54 offen offset:0
    buffer_load_ushort v37, v127, s[24:27], s54 offen offset:1280
    buffer_load_ushort v38, v127, s[24:27], s54 offen offset:2560
    buffer_load_ushort v39, v127, s[24:27], s54 offen offset:3840
    s_add_u32 s54, s54, 32
    s_cmp_gt_i32 s39, 5
    s_cbranch_scc0 L_proj_rp_ld
    buffer_load_ushort v40, v126, s[24:27], s54 offen offset:0
    buffer_load_ushort v41, v126, s[24:27], s54 offen offset:1280
    buffer_load_ushort v42, v126, s[24:27], s54 offen offset:2560
    buffer_load_ushort v43, v126, s[24:27], s54 offen offset:3840
    buffer_load_ushort v44, v127, s[24:27], s54 offen offset:0
    buffer_load_ushort v45, v127, s[24:27], s54 offen offset:1280
    buffer_load_ushort v46, v127, s[24:27], s54 offen offset:2560
    buffer_load_ushort v47, v127, s[24:27], s54 offen offset:3840
    s_add_u32 s54, s54, 32
    s_cmp_gt_i32 s39, 6
    s_cbranch_scc0 L_proj_rp_ld
    buffer_load_ushort v48, v126, s[24:27], s54 offen offset:0
    buffer_load_ushort v49, v126, s[24:27], s54 offen offset:1280
    buffer_load_ushort v50, v126, s[24:27], s54 offen offset:2560
    buffer_load_ushort v51, v126, s[24:27], s54 offen offset:3840
    buffer_load_ushort v52, v127, s[24:27], s54 offen offset:0
    buffer_load_ushort v53, v127, s[24:27], s54 offen offset:1280
    buffer_load_ushort v54, v127, s[24:27], s54 offen offset:2560
    buffer_load_ushort v55, v127, s[24:27], s54 offen offset:3840
    s_add_u32 s54, s54, 32
L_proj_rp_ld:
    s_barrier
    s_barrier
    s_waitcnt vmcnt(0)
    s_cmp_gt_i32 s39, 0
    s_cbranch_scc0 L_proj_rp_st
    v_lshl_or_b32 v0, v1, 16, v0
    v_lshl_or_b32 v1, v3, 16, v2
    v_lshl_or_b32 v2, v5, 16, v4
    v_lshl_or_b32 v3, v7, 16, v6
    buffer_store_dwordx4 v[0:3], v124, s[28:31], s55 offen nt
    s_add_u32 s55, s55, 1024
    s_cmp_gt_i32 s39, 1
    s_cbranch_scc0 L_proj_rp_st
    v_lshl_or_b32 v8, v9, 16, v8
    v_lshl_or_b32 v9, v11, 16, v10
    v_lshl_or_b32 v10, v13, 16, v12
    v_lshl_or_b32 v11, v15, 16, v14
    buffer_store_dwordx4 v[8:11], v124, s[28:31], s55 offen nt
    s_add_u32 s55, s55, 1024
    s_cmp_gt_i32 s39, 2
    s_cbranch_scc0 L_proj_rp_st
    v_lshl_or_b32 v16, v17, 16, v16
    v_lshl_or_b32 v17, v19, 16, v18
    v_lshl_or_b32 v18, v21, 16, v20
    v_lshl_or_b32 v19, v23, 16, v22
    buffer_store_dwordx4 v[16:19], v124, s[28:31], s55 offen nt
    s_add_u32 s55, s55, 1024
    s_cmp_gt_i32 s39, 3
    s_cbranch_scc0 L_proj_rp_st
    v_lshl_or_b32 v24, v25, 16, v24
    v_lshl_or_b32 v25, v27, 16, v26
    v_lshl_or_b32 v26, v29, 16, v28
    v_lshl_or_b32 v27, v31, 16, v30
    buffer_store_dwordx4 v[24:27], v124, s[28:31], s55 offen nt
    s_add_u32 s55, s55, 1024
    s_cmp_gt_i32 s39, 4
    s_cbranch_scc0 L_proj_rp_st
    v_lshl_or_b32 v32, v33, 16, v32
    v_lshl_or_b32 v33, v35, 16, v34
    v_lshl_or_b32 v34, v37, 16, v36
    v_lshl_or_b32 v35, v39, 16, v38
    buffer_store_dwordx4 v[32:35], v124, s[28:31], s55 offen nt
    s_add_u32 s55, s55, 1024
    s_cmp_gt_i32 s39, 5
    s_cbranch_scc0 L_proj_rp_st
    v_lshl_or_b32 v40, v41, 16, v40
    v_lshl_or_b32 v41, v43, 16, v42
    v_lshl_or_b32 v42, v45, 16, v44
    v_lshl_or_b32 v43, v47, 16, v46
    buffer_store_dwordx4 v[40:43], v124, s[28:31], s55 offen nt
    s_add_u32 s55, s55, 1024
    s_cmp_gt_i32 s39, 6
    s_cbranch_scc0 L_proj_rp_st
    v_lshl_or_b32 v48, v49, 16, v48
    v_lshl_or_b32 v49, v51, 16, v50
    v_lshl_or_b32 v50, v53, 16, v52
    v_lshl_or_b32 v51, v55, 16, v54
    buffer_store_dwordx4 v[48:51], v124, s[28:31], s55 offen nt
    s_add_u32 s55, s55, 1024
L_proj_rp_st:
    s_sub_u32 s40, s2, 240
    s_cmp_lt_u32 s40, 8
    s_cbranch_scc0 L_proj_rp_end
    s_lshl_b32 s40, s40, 10
    s_add_u32 s40, s40, 18890752
    v_mov_b32 v0, 0
    v_mov_b32 v1, 0
    v_mov_b32 v2, 0
    v_mov_b32 v3, 0
    buffer_store_dwordx4 v[0:3], v124, s[28:31], s40 offen
L_proj_rp_end:
    s_endpgm
L_proj_main:
    s_cmp_ge_u32 s36, 10
    s_cbranch_scc0 L_proj_cons
    s_sub_u32 s57, s36, 10
    v_lshrrev_b32 v124, 3, v123
    v_lshrrev_b32 v125, 4, v123
    v_and_b32 v126, 7, v123
    v_xor_b32 v126, v126, v125
    v_lshlrev_b32 v126, 4, v126
    s_lshl_b32 s39, s37, 7
    s_lshl_b32 s40, s57, 5
    s_add_u32 s39, s39, s40
    v_add_u32 v124, s39, v124
    v_mul_u32_u24 v124, 1280, v124
    v_add_u32 v0, v124, v126
    v_xor_b32 v126, 64, v126
    v_add_u32 v1, v124, v126
    v_add_u32 v1, 10240, v1
    v_add_u32 v2, 20480, v0
    v_add_u32 v3, 20480, v1
    s_mov_b32 s43, 0
    s_lshl_b32 s45, s57, 12
    s_add_u32 m0, s45, 0
    s_nop 0
    buffer_load_dwordx4 v0, s[20:23], s43 offen lds
    s_add_u32 m0, s45, 1024
    s_nop 0
    buffer_load_dwordx4 v1, s[20:23], s43 offen lds
    s_add_u32 m0, s45, 2048
    s_nop 0
    buffer_load_dwordx4 v2, s[20:23], s43 offen lds
    s_add_u32 m0, s45, 3072
    s_nop 0
    buffer_load_dwordx4 v3, s[20:23], s43 offen lds
    s_mul_i32 s39, s57, 320
    v_add_u32 v124, s39, v123
    v_mul_u32_u24 v125, 3277, v124
    v_lshrrev_b32 v125, 16, v125
    v_mul_u32_u24 v126, 20, v125
    v_sub_u32 v126, v124, v126
    v_mul_u32_u24 v125, s42, v125
    v_lshl_add_u32 v4, v126, 4, v125
    v_add_u32 v124, s39, v123
    v_add_u32 v124, 64, v124
    v_mul_u32_u24 v125, 3277, v124
    v_lshrrev_b32 v125, 16, v125
    v_mul_u32_u24 v126, 20, v125
    v_sub_u32 v126, v124, v126
    v_mul_u32_u24 v125, s42, v125
    v_lshl_add_u32 v5, v126, 4, v125
    v_add_u32 v124, s39, v123
    v_add_u32 v124, 128, v124
    v_mul_u32_u24 v125, 3277, v124
    v_lshrrev_b32 v125, 16, v125
    v_mul_u32_u24 v126, 20, v125
    v_sub_u32 v126, v124, v126
    v_mul_u32_u24 v125, s42, v125
    v_lshl_add_u32 v6, v126, 4, v125
    v_add_u32 v124, s39, v123
    v_add_u32 v124, 192, v124
    v_mul_u32_u24 v125, 3277, v124
    v_lshrrev_b32 v125, 16, v125
    v_mul_u32_u24 v126, 20, v125
    v_sub_u32 v126, v124, v126
    v_mul_u32_u24 v125, s42, v125
    v_lshl_add_u32 v7, v126, 4, v125
    v_add_u32 v124, s39, v123
    v_add_u32 v124, 256, v124
    v_mul_u32_u24 v125, 3277, v124
    v_lshrrev_b32 v125, 16, v125
    v_mul_u32_u24 v126, 20, v125
    v_sub_u32 v126, v124, v126
    v_mul_u32_u24 v125, s42, v125
    v_lshl_add_u32 v8, v126, 4, v125
    s_mul_i32 s46, s57, 5120
    s_add_u32 s46, s46, 65536
    s_lshl_b32 s42, s42, 6
    s_add_u32 m0, s46, 0
    s_nop 0
    buffer_load_dwordx4 v4, s[24:27], s44 offen lds
    s_add_u32 m0, s46, 1024
    s_nop 0
    buffer_load_dwordx4 v5, s[24:27], s44 offen lds
    s_add_u32 m0, s46, 2048
    s_nop 0
    buffer_load_dwordx4 v6, s[24:27], s44 offen lds
    s_add_u32 m0, s46, 3072
    s_nop 0
    buffer_load_dwordx4 v7, s[24:27], s44 offen lds
    s_add_u32 m0, s46, 4096
    s_nop 0
    buffer_load_dwordx4 v8, s[24:27], s44 offen lds
    s_add_u32 s43, s43, 128
    s_add_u32 s44, s44, s42
    s_add_u32 s45, s45, 16384
    s_and_b32 s45, s45, 0xffff
    s_add_u32 s46, s46, 20480
    s_sub_u32 s39, s46, 81920
    s_cmp_ge_u32 s46, 147456
    s_cselect_b32 s46, s39, s46
    s_add_u32 m0, s45, 0
    s_nop 0
    buffer_load_dwordx4 v0, s[20:23], s43 offen lds
    s_add_u32 m0, s45, 1024
    s_nop 0
    buffer_load_dwordx4 v1, s[20:23], s43 offen lds
    s_add_u32 m0, s45, 2048
    s_nop 0
    buffer_load_dwordx4 v2, s[20:23], s43 offen lds
    s_add_u32 m0, s45, 3072
    s_nop 0
    buffer_load_dwordx4 v3, s[20:23], s43 offen lds
    s_add_u32 m0, s46, 0
    s_nop 0
    buffer_load_dwordx4 v4, s[24:27], s44 offen lds
    s_add_u32 m0, s46, 1024
    s_nop 0
    buffer_load_dwordx4 v5, s[24:27], s44 offen lds
    s_add_u32 m0, s46, 2048
    s_nop 0
    buffer_load_dwordx4 v6, s[24:27], s44 offen lds
    s_add_u32 m0, s46, 3072
    s_nop 0
    buffer_load_dwordx4 v7, s[24:27], s44 offen lds
    s_add_u32 m0, s46, 4096
    s_nop 0
    buffer_load_dwordx4 v8, s[24:27], s44 offen lds
    s_waitcnt vmcnt(9)
    s_barrier
    s_mov_b32 s41, 0
L_proj_ploop:
    s_add_u32 s43, s43, 128
    s_add_u32 s44, s44, s42
    s_add_u32 s45, s45, 16384
    s_and_b32 s45, s45, 0xffff
    s_add_u32 s46, s46, 20480
    s_sub_u32 s39, s46, 81920
    s_cmp_ge_u32 s46, 147456
    s_cselect_b32 s46, s39, s46
    s_add_u32 m0, s45, 0
    s_nop 0
    buffer_load_dwordx4 v0, s[20:23], s43 offen lds
    s_add_u32 m0, s45, 1024
    s_nop 0
    buffer_load_dwordx4 v1, s[20:23], s43 offen lds
    s_add_u32 m0, s45, 2048
    s_nop 0
    buffer_load_dwordx4 v2, s[20:23], s43 offen lds
    s_add_u32 m0, s45, 3072
    s_nop 0
    buffer_load_dwordx4 v3, s[20:23], s43 offen lds
    s_add_u32 m0, s46, 0
    s_nop 0
    buffer_load_dwordx4 v4, s[24:27], s44 offen lds
    s_add_u32 m0, s46, 1024
    s_nop 0
    buffer_load_dwordx4 v5, s[24:27], s44 offen lds
    s_add_u32 m0, s46, 2048
    s_nop 0
    buffer_load_dwordx4 v6, s[24:27], s44 offen lds
    s_add_u32 m0, s46, 3072
    s_nop 0
    buffer_load_dwordx4 v7, s[24:27], s44 offen lds
    s_add_u32 m0, s46, 4096
    s_nop 0
    buffer_load_dwordx4 v8, s[24:27], s44 offen lds
    s_waitcnt vmcnt(9)
    s_barrier
    s_add_u32 s41, s41, 1
    s_cmp_lt_u32 s41, 8
    s_cbranch_scc1 L_proj_ploop
    s_waitcnt vmcnt(0)
    s_barrier
    s_barrier
    s_endpgm
L_proj_cons:
    s_cmp_ge_u32 s36, 4
    s_cbranch_scc1 L_proj_cp1
    v_and_b32 v124, 31, v123
    v_lshrrev_b32 v125, 5, v123
    v_bfe_u32 v126, v124, 1, 3
    v_xor_b32 v126, v126, v125
    v_lshlrev_b32 v126, 4, v126
    s_lshl_b32 s39, s57, 12
    v_lshl_add_u32 v126, v124, 7, v126
    v_add_u32 v68, s39, v126
    v_xor_b32 v69, 32, v68
    v_xor_b32 v70, 64, v68
    v_xor_b32 v71, 96, v68
    v_bfe_u32 v126, v123, 2, 2
    v_lshl_add_u32 v126, v125, 3, v126
    v_mul_u32_u24 v126, 320, v126
    v_add_u32 v126, 65536, v126
    v_bfe_u32 v127, v123, 4, 1
    v_mul_u32_u24 v124, 160, v127
    v_add_u32 v76, v126, v124
    v_and_b32 v124, 1, v123
    v_lshl_add_u32 v76, v124, 4, v76
    v_bfe_u32 v124, v123, 1, 1
    v_lshl_add_u32 v76, v124, 3, v76
    v_and_b32 v124, 3, v123
    v_lshl_add_u32 v124, v127, 2, v124
    v_mul_u32_u24 v124, 40, v124
    v_add3_u32 v77, v126, v124, 32
    v_mov_b32 v72, v68
    v_mov_b32 v73, v69
    v_mov_b32 v74, v70
    v_mov_b32 v75, v71
    v_mov_b32 v78, v76
    v_mov_b32 v79, v77
    s_mov_b32 s47, 0
    s_mov_b32 s48, 0
    v_mov_b32 v0, 0
    v_mov_b32 v1, 0
    v_mov_b32 v2, 0
    v_mov_b32 v3, 0
    v_mov_b32 v4, 0
    v_mov_b32 v5, 0
    v_mov_b32 v6, 0
    v_mov_b32 v7, 0
    v_mov_b32 v8, 0
    v_mov_b32 v9, 0
    v_mov_b32 v10, 0
    v_mov_b32 v11, 0
    v_mov_b32 v12, 0
    v_mov_b32 v13, 0
    v_mov_b32 v14, 0
    v_mov_b32 v15, 0
    v_mov_b32 v16, 0
    v_mov_b32 v17, 0
    v_mov_b32 v18, 0
    v_mov_b32 v19, 0
    v_mov_b32 v20, 0
    v_mov_b32 v21, 0
    v_mov_b32 v22, 0
    v_mov_b32 v23, 0
    v_mov_b32 v24, 0
    v_mov_b32 v25, 0
    v_mov_b32 v26, 0
    v_mov_b32 v27, 0
    v_mov_b32 v28, 0
    v_mov_b32 v29, 0
    v_mov_b32 v30, 0
    v_mov_b32 v31, 0
    v_mov_b32 v32, 0
    v_mov_b32 v33, 0
    v_mov_b32 v34, 0
    v_mov_b32 v35, 0
    v_mov_b32 v36, 0
    v_mov_b32 v37, 0
    v_mov_b32 v38, 0
    v_mov_b32 v39, 0
    v_mov_b32 v40, 0
    v_mov_b32 v41, 0
    v_mov_b32 v42, 0
    v_mov_b32 v43, 0
    v_mov_b32 v44, 0
    v_mov_b32 v45, 0
    v_mov_b32 v46, 0
    v_mov_b32 v47, 0
    s_mov_b32 s41, 0
    s_barrier
    ds_read_b128 v[48:51], v72
    ds_read_b64_tr_b16 v[56:57], v78 offset:0
    ds_read_b64_tr_b16 v[58:59], v78 offset:1280
    ds_read_b64_tr_b16 v[60:61], v78 offset:40
    ds_read_b64_tr_b16 v[62:63], v78 offset:1320
    ds_read_b64_tr_b16 v[64:65], v78 offset:80
    ds_read_b64_tr_b16 v[66:67], v78 offset:1360
    s_cmp_ge_u32 s38, 8
    s_cbranch_scc0 L_proj_loop_qk0
    s_cmp_lt_u32 s38, 12
    s_cbranch_scc1 L_proj_loop_v0
L_proj_loop_qk0:
    ds_read_b128 v[52:55], v73
    s_waitcnt lgkmcnt(5)
    v_mfma_f32_32x32x16_bf16 v[0:15], v[56:59], v[48:51], v[0:15]
    ds_read_b64_tr_b16 v[56:57], v78 offset:5120
    ds_read_b64_tr_b16 v[58:59], v78 offset:6400
    s_waitcnt lgkmcnt(5)
    v_mfma_f32_32x32x16_bf16 v[16:31], v[60:63], v[48:51], v[16:31]
    ds_read_b64_tr_b16 v[60:61], v78 offset:5160
    ds_read_b64_tr_b16 v[62:63], v78 offset:6440
    s_waitcnt lgkmcnt(5)
    v_mfma_f32_32x32x16_bf16 v[32:47], v[64:67], v[48:51], v[32:47]
    ds_read_b64_tr_b16 v[64:65], v78 offset:5200
    ds_read_b64_tr_b16 v[66:67], v78 offset:6480
    s_add_u32 s47, s47, 16384
    s_and_b32 s47, s47, 0xffff
    s_add_u32 s48, s48, 20480
    s_cmp_ge_u32 s48, 81920
    s_cselect_b32 s48, 0, s48
    v_add_u32 v72, s47, v68
    v_add_u32 v73, s47, v69
    ds_read_b128 v[48:51], v74
    s_waitcnt lgkmcnt(5)
    v_mfma_f32_32x32x16_bf16 v[0:15], v[56:59], v[52:55], v[0:15]
    ds_read_b64_tr_b16 v[56:57], v78 offset:10240
    ds_read_b64_tr_b16 v[58:59], v78 offset:11520
    s_waitcnt lgkmcnt(5)
    v_mfma_f32_32x32x16_bf16 v[16:31], v[60:63], v[52:55], v[16:31]
    ds_read_b64_tr_b16 v[60:61], v78 offset:10280
    ds_read_b64_tr_b16 v[62:63], v78 offset:11560
    s_waitcnt lgkmcnt(5)
    v_mfma_f32_32x32x16_bf16 v[32:47], v[64:67], v[52:55], v[32:47]
    ds_read_b64_tr_b16 v[64:65], v78 offset:10320
    ds_read_b64_tr_b16 v[66:67], v78 offset:11600
    v_add_u32 v74, s47, v70
    v_add_u32 v86, s48, v76
    ds_read_b128 v[52:55], v75
    s_waitcnt lgkmcnt(5)
    v_mfma_f32_32x32x16_bf16 v[0:15], v[56:59], v[48:51], v[0:15]
    ds_read_b64_tr_b16 v[56:57], v78 offset:15360
    ds_read_b64_tr_b16 v[58:59], v78 offset:16640
    s_waitcnt lgkmcnt(5)
    v_mfma_f32_32x32x16_bf16 v[16:31], v[60:63], v[48:51], v[16:31]
    ds_read_b64_tr_b16 v[60:61], v78 offset:15400
    ds_read_b64_tr_b16 v[62:63], v78 offset:16680
    s_waitcnt lgkmcnt(5)
    v_mfma_f32_32x32x16_bf16 v[32:47], v[64:67], v[48:51], v[32:47]
    ds_read_b64_tr_b16 v[64:65], v78 offset:15440
    ds_read_b64_tr_b16 v[66:67], v78 offset:16720
    v_add_u32 v75, s47, v71
    s_waitcnt lgkmcnt(0)
    s_barrier
    ds_read_b128 v[48:51], v72
    s_waitcnt lgkmcnt(5)
    v_mfma_f32_32x32x16_bf16 v[0:15], v[56:59], v[52:55], v[0:15]
    ds_read_b64_tr_b16 v[56:57], v86 offset:0
    ds_read_b64_tr_b16 v[58:59], v86 offset:1280
    s_waitcnt lgkmcnt(5)
    v_mfma_f32_32x32x16_bf16 v[16:31], v[60:63], v[52:55], v[16:31]
    ds_read_b64_tr_b16 v[60:61], v86 offset:40
    ds_read_b64_tr_b16 v[62:63], v86 offset:1320
    s_waitcnt lgkmcnt(5)
    v_mfma_f32_32x32x16_bf16 v[32:47], v[64:67], v[52:55], v[32:47]
    ds_read_b64_tr_b16 v[64:65], v86 offset:80
    ds_read_b64_tr_b16 v[66:67], v86 offset:1360
    v_mov_b32 v78, v86
    s_add_u32 s41, s41, 1
    s_cmp_lt_u32 s41, 10
    s_cbranch_scc1 L_proj_loop_qk0
    s_and_b32 s56, s57, 1
    s_lshl_b32 s39, s37, 1
    s_lshr_b32 s40, s57, 1
    s_add_u32 s39, s39, s40
    s_lshr_b32 s40, s38, 2
    s_cmp_eq_u32 s40, 1
    s_mov_b32 s54, 163840
    s_cselect_b32 s54, s54, 81920
    s_mov_b32 s53, 5120
    s_cselect_b32 s53, s53, 2560
    s_mov_b32 s40, 0
    s_cselect_b32 s40, s40, 6291456
    s_cselect_b32 s55, 1.0, 0x3ea52b5c
    s_mul_i32 s52, s39, s53
    s_add_u32 s52, s52, s40
    s_and_b32 s39, s38, 3
    s_lshl_b32 s39, s39, 3
    s_cmp_ge_u32 s38, 12
    s_cselect_b32 s40, 32, 0
    s_add_u32 s39, s39, s40
    s_mul_i32 s39, s39, s54
    s_add_u32 s52, s52, s39
    s_lshl_b32 s39, s56, 3
    s_add_u32 s53, s52, s39
    s_lshl_b32 s39, s56, 10
    s_add_u32 s52, s52, s39
    v_lshlrev_b32 v88, 4, v123
    v_and_b32 v124, 31, v123
    v_lshlrev_b32 v124, 4, v124
    v_lshrrev_b32 v125, 5, v123
    v_mul_u32_u24 v125, s54, v125
    v_add_u32 v89, v124, v125
    s_cmp_lg_u32 s54, 163840
    s_cbranch_scc1 L_proj_qkhot0
    s_cmp_lt_u32 s37, 2
    s_cbranch_scc1 L_proj_qkhot0
    v_mul_f32 v0, s55, v0
    v_mul_f32 v1, s55, v1
    v_mul_f32 v2, s55, v2
    v_mul_f32 v3, s55, v3
    v_mul_f32 v4, s55, v4
    v_mul_f32 v5, s55, v5
    v_mul_f32 v6, s55, v6
    v_mul_f32 v7, s55, v7
    v_cvt_pk_bf16_f32 v0, v0, v1
    v_cvt_pk_bf16_f32 v1, v2, v3
    v_cvt_pk_bf16_f32 v2, v4, v5
    v_cvt_pk_bf16_f32 v3, v6, v7
    s_mul_i32 s39, s54, 0
    s_add_u32 s39, s39, s52
    buffer_store_dwordx4 v[0:3], v88, s[28:31], s39 offen nt
    v_mul_f32 v8, s55, v8
    v_mul_f32 v9, s55, v9
    v_mul_f32 v10, s55, v10
    v_mul_f32 v11, s55, v11
    v_mul_f32 v12, s55, v12
    v_mul_f32 v13, s55, v13
    v_mul_f32 v14, s55, v14
    v_mul_f32 v15, s55, v15
    v_cvt_pk_bf16_f32 v8, v8, v9
    v_cvt_pk_bf16_f32 v9, v10, v11
    v_cvt_pk_bf16_f32 v10, v12, v13
    v_cvt_pk_bf16_f32 v11, v14, v15
    s_mul_i32 s39, s54, 4
    s_add_u32 s39, s39, s52
    buffer_store_dwordx4 v[8:11], v88, s[28:31], s39 offen nt
    v_mul_f32 v16, s55, v16
    v_mul_f32 v17, s55, v17
    v_mul_f32 v18, s55, v18
    v_mul_f32 v19, s55, v19
    v_mul_f32 v20, s55, v20
    v_mul_f32 v21, s55, v21
    v_mul_f32 v22, s55, v22
    v_mul_f32 v23, s55, v23
    v_cvt_pk_bf16_f32 v16, v16, v17
    v_cvt_pk_bf16_f32 v17, v18, v19
    v_cvt_pk_bf16_f32 v18, v20, v21
    v_cvt_pk_bf16_f32 v19, v22, v23
    s_mul_i32 s39, s54, 1
    s_add_u32 s39, s39, s52
    buffer_store_dwordx4 v[16:19], v88, s[28:31], s39 offen nt
    v_mul_f32 v24, s55, v24
    v_mul_f32 v25, s55, v25
    v_mul_f32 v26, s55, v26
    v_mul_f32 v27, s55, v27
    v_mul_f32 v28, s55, v28
    v_mul_f32 v29, s55, v29
    v_mul_f32 v30, s55, v30
    v_mul_f32 v31, s55, v31
    v_cvt_pk_bf16_f32 v24, v24, v25
    v_cvt_pk_bf16_f32 v25, v26, v27
    v_cvt_pk_bf16_f32 v26, v28, v29
    v_cvt_pk_bf16_f32 v27, v30, v31
    s_mul_i32 s39, s54, 5
    s_add_u32 s39, s39, s52
    buffer_store_dwordx4 v[24:27], v88, s[28:31], s39 offen nt
    v_mul_f32 v32, s55, v32
    v_mul_f32 v33, s55, v33
    v_mul_f32 v34, s55, v34
    v_mul_f32 v35, s55, v35
    v_mul_f32 v36, s55, v36
    v_mul_f32 v37, s55, v37
    v_mul_f32 v38, s55, v38
    v_mul_f32 v39, s55, v39
    v_cvt_pk_bf16_f32 v32, v32, v33
    v_cvt_pk_bf16_f32 v33, v34, v35
    v_cvt_pk_bf16_f32 v34, v36, v37
    v_cvt_pk_bf16_f32 v35, v38, v39
    s_mul_i32 s39, s54, 2
    s_add_u32 s39, s39, s52
    buffer_store_dwordx4 v[32:35], v88, s[28:31], s39 offen nt
    v_mul_f32 v40, s55, v40
    v_mul_f32 v41, s55, v41
    v_mul_f32 v42, s55, v42
    v_mul_f32 v43, s55, v43
    v_mul_f32 v44, s55, v44
    v_mul_f32 v45, s55, v45
    v_mul_f32 v46, s55, v46
    v_mul_f32 v47, s55, v47
    v_cvt_pk_bf16_f32 v40, v40, v41
    v_cvt_pk_bf16_f32 v41, v42, v43
    v_cvt_pk_bf16_f32 v42, v44, v45
    v_cvt_pk_bf16_f32 v43, v46, v47
    s_mul_i32 s39, s54, 6
    s_add_u32 s39, s39, s52
    buffer_store_dwordx4 v[40:43], v88, s[28:31], s39 offen nt
    s_endpgm
L_proj_qkhot0:
    v_mul_f32 v0, s55, v0
    v_mul_f32 v1, s55, v1
    v_mul_f32 v2, s55, v2
    v_mul_f32 v3, s55, v3
    v_mul_f32 v4, s55, v4
    v_mul_f32 v5, s55, v5
    v_mul_f32 v6, s55, v6
    v_mul_f32 v7, s55, v7
    v_cvt_pk_bf16_f32 v0, v0, v1
    v_cvt_pk_bf16_f32 v1, v2, v3
    v_cvt_pk_bf16_f32 v2, v4, v5
    v_cvt_pk_bf16_f32 v3, v6, v7
    s_mul_i32 s39, s54, 0
    s_add_u32 s39, s39, s52
    buffer_store_dwordx4 v[0:3], v88, s[28:31], s39 offen
    v_mul_f32 v8, s55, v8
    v_mul_f32 v9, s55, v9
    v_mul_f32 v10, s55, v10
    v_mul_f32 v11, s55, v11
    v_mul_f32 v12, s55, v12
    v_mul_f32 v13, s55, v13
    v_mul_f32 v14, s55, v14
    v_mul_f32 v15, s55, v15
    v_cvt_pk_bf16_f32 v8, v8, v9
    v_cvt_pk_bf16_f32 v9, v10, v11
    v_cvt_pk_bf16_f32 v10, v12, v13
    v_cvt_pk_bf16_f32 v11, v14, v15
    s_mul_i32 s39, s54, 4
    s_add_u32 s39, s39, s52
    buffer_store_dwordx4 v[8:11], v88, s[28:31], s39 offen
    v_mul_f32 v16, s55, v16
    v_mul_f32 v17, s55, v17
    v_mul_f32 v18, s55, v18
    v_mul_f32 v19, s55, v19
    v_mul_f32 v20, s55, v20
    v_mul_f32 v21, s55, v21
    v_mul_f32 v22, s55, v22
    v_mul_f32 v23, s55, v23
    v_cvt_pk_bf16_f32 v16, v16, v17
    v_cvt_pk_bf16_f32 v17, v18, v19
    v_cvt_pk_bf16_f32 v18, v20, v21
    v_cvt_pk_bf16_f32 v19, v22, v23
    s_mul_i32 s39, s54, 1
    s_add_u32 s39, s39, s52
    buffer_store_dwordx4 v[16:19], v88, s[28:31], s39 offen
    v_mul_f32 v24, s55, v24
    v_mul_f32 v25, s55, v25
    v_mul_f32 v26, s55, v26
    v_mul_f32 v27, s55, v27
    v_mul_f32 v28, s55, v28
    v_mul_f32 v29, s55, v29
    v_mul_f32 v30, s55, v30
    v_mul_f32 v31, s55, v31
    v_cvt_pk_bf16_f32 v24, v24, v25
    v_cvt_pk_bf16_f32 v25, v26, v27
    v_cvt_pk_bf16_f32 v26, v28, v29
    v_cvt_pk_bf16_f32 v27, v30, v31
    s_mul_i32 s39, s54, 5
    s_add_u32 s39, s39, s52
    buffer_store_dwordx4 v[24:27], v88, s[28:31], s39 offen
    v_mul_f32 v32, s55, v32
    v_mul_f32 v33, s55, v33
    v_mul_f32 v34, s55, v34
    v_mul_f32 v35, s55, v35
    v_mul_f32 v36, s55, v36
    v_mul_f32 v37, s55, v37
    v_mul_f32 v38, s55, v38
    v_mul_f32 v39, s55, v39
    v_cvt_pk_bf16_f32 v32, v32, v33
    v_cvt_pk_bf16_f32 v33, v34, v35
    v_cvt_pk_bf16_f32 v34, v36, v37
    v_cvt_pk_bf16_f32 v35, v38, v39
    s_mul_i32 s39, s54, 2
    s_add_u32 s39, s39, s52
    buffer_store_dwordx4 v[32:35], v88, s[28:31], s39 offen
    v_mul_f32 v40, s55, v40
    v_mul_f32 v41, s55, v41
    v_mul_f32 v42, s55, v42
    v_mul_f32 v43, s55, v43
    v_mul_f32 v44, s55, v44
    v_mul_f32 v45, s55, v45
    v_mul_f32 v46, s55, v46
    v_mul_f32 v47, s55, v47
    v_cvt_pk_bf16_f32 v40, v40, v41
    v_cvt_pk_bf16_f32 v41, v42, v43
    v_cvt_pk_bf16_f32 v42, v44, v45
    v_cvt_pk_bf16_f32 v43, v46, v47
    s_mul_i32 s39, s54, 6
    s_add_u32 s39, s39, s52
    buffer_store_dwordx4 v[40:43], v88, s[28:31], s39 offen
    s_endpgm
L_proj_loop_v0:
    ds_read_b128 v[52:55], v73
    s_waitcnt lgkmcnt(5)
    v_mfma_f32_32x32x16_bf16 v[0:15], v[48:51], v[56:59], v[0:15]
    ds_read_b64_tr_b16 v[56:57], v78 offset:5120
    ds_read_b64_tr_b16 v[58:59], v78 offset:6400
    s_waitcnt lgkmcnt(5)
    v_mfma_f32_32x32x16_bf16 v[16:31], v[48:51], v[60:63], v[16:31]
    ds_read_b64_tr_b16 v[60:61], v78 offset:5160
    ds_read_b64_tr_b16 v[62:63], v78 offset:6440
    s_waitcnt lgkmcnt(5)
    v_mfma_f32_32x32x16_bf16 v[32:47], v[48:51], v[64:67], v[32:47]
    ds_read_b64_tr_b16 v[64:65], v78 offset:5200
    ds_read_b64_tr_b16 v[66:67], v78 offset:6480
    s_add_u32 s47, s47, 16384
    s_and_b32 s47, s47, 0xffff
    s_add_u32 s48, s48, 20480
    s_cmp_ge_u32 s48, 81920
    s_cselect_b32 s48, 0, s48
    v_add_u32 v72, s47, v68
    v_add_u32 v73, s47, v69
    ds_read_b128 v[48:51], v74
    s_waitcnt lgkmcnt(5)
    v_mfma_f32_32x32x16_bf16 v[0:15], v[52:55], v[56:59], v[0:15]
    ds_read_b64_tr_b16 v[56:57], v78 offset:10240
    ds_read_b64_tr_b16 v[58:59], v78 offset:11520
    s_waitcnt lgkmcnt(5)
    v_mfma_f32_32x32x16_bf16 v[16:31], v[52:55], v[60:63], v[16:31]
    ds_read_b64_tr_b16 v[60:61], v78 offset:10280
    ds_read_b64_tr_b16 v[62:63], v78 offset:11560
    s_waitcnt lgkmcnt(5)
    v_mfma_f32_32x32x16_bf16 v[32:47], v[52:55], v[64:67], v[32:47]
    ds_read_b64_tr_b16 v[64:65], v78 offset:10320
    ds_read_b64_tr_b16 v[66:67], v78 offset:11600
    v_add_u32 v74, s47, v70
    v_add_u32 v86, s48, v76
    ds_read_b128 v[52:55], v75
    s_waitcnt lgkmcnt(5)
    v_mfma_f32_32x32x16_bf16 v[0:15], v[48:51], v[56:59], v[0:15]
    ds_read_b64_tr_b16 v[56:57], v78 offset:15360
    ds_read_b64_tr_b16 v[58:59], v78 offset:16640
    s_waitcnt lgkmcnt(5)
    v_mfma_f32_32x32x16_bf16 v[16:31], v[48:51], v[60:63], v[16:31]
    ds_read_b64_tr_b16 v[60:61], v78 offset:15400
    ds_read_b64_tr_b16 v[62:63], v78 offset:16680
    s_waitcnt lgkmcnt(5)
    v_mfma_f32_32x32x16_bf16 v[32:47], v[48:51], v[64:67], v[32:47]
    ds_read_b64_tr_b16 v[64:65], v78 offset:15440
    ds_read_b64_tr_b16 v[66:67], v78 offset:16720
    v_add_u32 v75, s47, v71
    s_waitcnt lgkmcnt(0)
    s_barrier
    ds_read_b128 v[48:51], v72
    s_waitcnt lgkmcnt(5)
    v_mfma_f32_32x32x16_bf16 v[0:15], v[52:55], v[56:59], v[0:15]
    ds_read_b64_tr_b16 v[56:57], v86 offset:0
    ds_read_b64_tr_b16 v[58:59], v86 offset:1280
    s_waitcnt lgkmcnt(5)
    v_mfma_f32_32x32x16_bf16 v[16:31], v[52:55], v[60:63], v[16:31]
    ds_read_b64_tr_b16 v[60:61], v86 offset:40
    ds_read_b64_tr_b16 v[62:63], v86 offset:1320
    s_waitcnt lgkmcnt(5)
    v_mfma_f32_32x32x16_bf16 v[32:47], v[52:55], v[64:67], v[32:47]
    ds_read_b64_tr_b16 v[64:65], v86 offset:80
    ds_read_b64_tr_b16 v[66:67], v86 offset:1360
    v_mov_b32 v78, v86
    s_add_u32 s41, s41, 1
    s_cmp_lt_u32 s41, 10
    s_cbranch_scc1 L_proj_loop_v0
    s_and_b32 s56, s57, 1
    s_lshl_b32 s39, s37, 1
    s_lshr_b32 s40, s57, 1
    s_add_u32 s39, s39, s40
    s_mul_i32 s52, s39, 5120
    s_mul_i32 s39, s56, 1280
    s_add_u32 s52, s52, s39
    s_and_b32 s39, s38, 3
    s_mul_i32 s39, s39, 1310720
    s_add_u32 s52, s52, s39
    s_add_u32 s52, s52, 2560
    s_mov_b32 s39, 163840
    v_lshrrev_b32 v125, 5, v123
    v_mul_u32_u24 v127, 320, v125
    v_and_b32 v124, 3, v123
    v_lshl_add_u32 v127, v124, 4, v127
    v_bfe_u32 v124, v123, 4, 1
    v_lshlrev_b32 v124, 2, v124
    v_mul_u32_u24 v124, s39, v124
    v_add_u32 v88, v127, v124
    v_bfe_u32 v124, v123, 2, 1
    v_lshl_add_u32 v88, v124, 7, v88
    v_bfe_u32 v124, v123, 3, 1
    v_lshl_add_u32 v88, v124, 6, v88
    v_bfe_u32 v124, v123, 2, 3
    v_mul_u32_u24 v124, s39, v124
    v_add3_u32 v89, v127, v124, 0
    s_cmp_lt_u32 s37, 2
    s_cbranch_scc1 L_proj_vhot0
    v_cvt_pk_bf16_f32 v0, v0, v1
    v_cvt_pk_bf16_f32 v1, v2, v3
    v_cvt_pk_bf16_f32 v2, v4, v5
    v_cvt_pk_bf16_f32 v3, v6, v7
    s_add_u32 s39, s52, 0
    buffer_store_dwordx4 v[0:3], v88, s[28:31], s39 offen offset:0 nt
    v_cvt_pk_bf16_f32 v8, v8, v9
    v_cvt_pk_bf16_f32 v9, v10, v11
    v_cvt_pk_bf16_f32 v10, v12, v13
    v_cvt_pk_bf16_f32 v11, v14, v15
    s_add_u32 s39, s52, 0
    buffer_store_dwordx4 v[8:11], v88, s[28:31], s39 offen offset:640 nt
    v_cvt_pk_bf16_f32 v16, v16, v17
    v_cvt_pk_bf16_f32 v17, v18, v19
    v_cvt_pk_bf16_f32 v18, v20, v21
    v_cvt_pk_bf16_f32 v19, v22, v23
    s_add_u32 s39, s52, 163840
    buffer_store_dwordx4 v[16:19], v88, s[28:31], s39 offen offset:0 nt
    v_cvt_pk_bf16_f32 v24, v24, v25
    v_cvt_pk_bf16_f32 v25, v26, v27
    v_cvt_pk_bf16_f32 v26, v28, v29
    v_cvt_pk_bf16_f32 v27, v30, v31
    s_add_u32 s39, s52, 163840
    buffer_store_dwordx4 v[24:27], v88, s[28:31], s39 offen offset:640 nt
    v_cvt_pk_bf16_f32 v32, v32, v33
    v_cvt_pk_bf16_f32 v33, v34, v35
    v_cvt_pk_bf16_f32 v34, v36, v37
    v_cvt_pk_bf16_f32 v35, v38, v39
    s_add_u32 s39, s52, 327680
    buffer_store_dwordx4 v[32:35], v88, s[28:31], s39 offen offset:0 nt
    v_cvt_pk_bf16_f32 v40, v40, v41
    v_cvt_pk_bf16_f32 v41, v42, v43
    v_cvt_pk_bf16_f32 v42, v44, v45
    v_cvt_pk_bf16_f32 v43, v46, v47
    s_add_u32 s39, s52, 327680
    buffer_store_dwordx4 v[40:43], v88, s[28:31], s39 offen offset:640 nt
    s_endpgm
L_proj_vhot0:
    v_cvt_pk_bf16_f32 v0, v0, v1
    v_cvt_pk_bf16_f32 v1, v2, v3
    v_cvt_pk_bf16_f32 v2, v4, v5
    v_cvt_pk_bf16_f32 v3, v6, v7
    s_add_u32 s39, s52, 0
    buffer_store_dwordx4 v[0:3], v88, s[28:31], s39 offen offset:0
    v_cvt_pk_bf16_f32 v8, v8, v9
    v_cvt_pk_bf16_f32 v9, v10, v11
    v_cvt_pk_bf16_f32 v10, v12, v13
    v_cvt_pk_bf16_f32 v11, v14, v15
    s_add_u32 s39, s52, 0
    buffer_store_dwordx4 v[8:11], v88, s[28:31], s39 offen offset:640
    v_cvt_pk_bf16_f32 v16, v16, v17
    v_cvt_pk_bf16_f32 v17, v18, v19
    v_cvt_pk_bf16_f32 v18, v20, v21
    v_cvt_pk_bf16_f32 v19, v22, v23
    s_add_u32 s39, s52, 163840
    buffer_store_dwordx4 v[16:19], v88, s[28:31], s39 offen offset:0
    v_cvt_pk_bf16_f32 v24, v24, v25
    v_cvt_pk_bf16_f32 v25, v26, v27
    v_cvt_pk_bf16_f32 v26, v28, v29
    v_cvt_pk_bf16_f32 v27, v30, v31
    s_add_u32 s39, s52, 163840
    buffer_store_dwordx4 v[24:27], v88, s[28:31], s39 offen offset:640
    v_cvt_pk_bf16_f32 v32, v32, v33
    v_cvt_pk_bf16_f32 v33, v34, v35
    v_cvt_pk_bf16_f32 v34, v36, v37
    v_cvt_pk_bf16_f32 v35, v38, v39
    s_add_u32 s39, s52, 327680
    buffer_store_dwordx4 v[32:35], v88, s[28:31], s39 offen offset:0
    v_cvt_pk_bf16_f32 v40, v40, v41
    v_cvt_pk_bf16_f32 v41, v42, v43
    v_cvt_pk_bf16_f32 v42, v44, v45
    v_cvt_pk_bf16_f32 v43, v46, v47
    s_add_u32 s39, s52, 327680
    buffer_store_dwordx4 v[40:43], v88, s[28:31], s39 offen offset:640
    s_endpgm
L_proj_cp1:
    v_and_b32 v124, 31, v123
    v_lshrrev_b32 v125, 5, v123
    v_bfe_u32 v126, v124, 1, 3
    v_xor_b32 v126, v126, v125
    v_lshlrev_b32 v126, 4, v126
    s_lshl_b32 s39, s57, 12
    v_lshl_add_u32 v126, v124, 7, v126
    v_add_u32 v68, s39, v126
    v_xor_b32 v69, 32, v68
    v_xor_b32 v70, 64, v68
    v_xor_b32 v71, 96, v68
    v_bfe_u32 v126, v123, 2, 2
    v_lshl_add_u32 v126, v125, 3, v126
    v_mul_u32_u24 v126, 320, v126
    v_add_u32 v126, 65536, v126
    v_bfe_u32 v127, v123, 4, 1
    v_mul_u32_u24 v124, 160, v127
    v_add_u32 v76, v126, v124
    v_and_b32 v124, 1, v123
    v_lshl_add_u32 v76, v124, 4, v76
    v_bfe_u32 v124, v123, 1, 1
    v_lshl_add_u32 v76, v124, 3, v76
    v_and_b32 v124, 3, v123
    v_lshl_add_u32 v124, v127, 2, v124
    v_mul_u32_u24 v124, 40, v124
    v_add3_u32 v77, v126, v124, 32
    v_mov_b32 v72, v68
    v_mov_b32 v73, v69
    v_mov_b32 v74, v70
    v_mov_b32 v75, v71
    v_mov_b32 v78, v76
    v_mov_b32 v79, v77
    s_mov_b32 s47, 0
    s_mov_b32 s48, 0
    v_mov_b32 v0, 0
    v_mov_b32 v1, 0
    v_mov_b32 v2, 0
    v_mov_b32 v3, 0
    v_mov_b32 v4, 0
    v_mov_b32 v5, 0
    v_mov_b32 v6, 0
    v_mov_b32 v7, 0
    v_mov_b32 v8, 0
    v_mov_b32 v9, 0
    v_mov_b32 v10, 0
    v_mov_b32 v11, 0
    v_mov_b32 v12, 0
    v_mov_b32 v13, 0
    v_mov_b32 v14, 0
    v_mov_b32 v15, 0
    v_mov_b32 v16, 0
    v_mov_b32 v17, 0
    v_mov_b32 v18, 0
    v_mov_b32 v19, 0
    v_mov_b32 v20, 0
    v_mov_b32 v21, 0
    v_mov_b32 v22, 0
    v_mov_b32 v23, 0
    v_mov_b32 v24, 0
    v_mov_b32 v25, 0
    v_mov_b32 v26, 0
    v_mov_b32 v27, 0
    v_mov_b32 v28, 0
    v_mov_b32 v29, 0
    v_mov_b32 v30, 0
    v_mov_b32 v31, 0
    v_mov_b32 v32, 0
    v_mov_b32 v33, 0
    v_mov_b32 v34, 0
    v_mov_b32 v35, 0
    v_mov_b32 v36, 0
    v_mov_b32 v37, 0
    v_mov_b32 v38, 0
    v_mov_b32 v39, 0
    v_mov_b32 v40, 0
    v_mov_b32 v41, 0
    v_mov_b32 v42, 0
    v_mov_b32 v43, 0
    v_mov_b32 v44, 0
    v_mov_b32 v45, 0
    v_mov_b32 v46, 0
    v_mov_b32 v47, 0
    s_mov_b32 s41, 0
    s_barrier
    ds_read_b128 v[48:51], v72
    ds_read_b64_tr_b16 v[56:57], v78 offset:120
    ds_read_b64_tr_b16 v[58:59], v78 offset:1400
    ds_read_b64_tr_b16 v[60:61], v79 offset:0
    ds_read_b64_tr_b16 v[62:63], v79 offset:1280
    s_cmp_ge_u32 s38, 8
    s_cbranch_scc0 L_proj_loop_qk1
    s_cmp_lt_u32 s38, 12
    s_cbranch_scc1 L_proj_loop_v1
L_proj_loop_qk1:
    ds_read_b128 v[52:55], v73
    s_waitcnt lgkmcnt(3)
    v_mfma_f32_32x32x16_bf16 v[0:15], v[56:59], v[48:51], v[0:15]
    ds_read_b64_tr_b16 v[56:57], v78 offset:5240
    ds_read_b64_tr_b16 v[58:59], v78 offset:6520
    s_waitcnt lgkmcnt(3)
    v_mfma_f32_32x32x16_bf16 v[16:31], v[60:63], v[48:51], v[16:31]
    ds_read_b64_tr_b16 v[60:61], v79 offset:5120
    ds_read_b64_tr_b16 v[62:63], v79 offset:6400
    s_add_u32 s47, s47, 16384
    s_and_b32 s47, s47, 0xffff
    s_add_u32 s48, s48, 20480
    s_cmp_ge_u32 s48, 81920
    s_cselect_b32 s48, 0, s48
    v_add_u32 v72, s47, v68
    v_add_u32 v73, s47, v69
    ds_read_b128 v[48:51], v74
    s_waitcnt lgkmcnt(3)
    v_mfma_f32_32x32x16_bf16 v[0:15], v[56:59], v[52:55], v[0:15]
    ds_read_b64_tr_b16 v[56:57], v78 offset:10360
    ds_read_b64_tr_b16 v[58:59], v78 offset:11640
    s_waitcnt lgkmcnt(3)
    v_mfma_f32_32x32x16_bf16 v[16:31], v[60:63], v[52:55], v[16:31]
    ds_read_b64_tr_b16 v[60:61], v79 offset:10240
    ds_read_b64_tr_b16 v[62:63], v79 offset:11520
    v_add_u32 v74, s47, v70
    v_add_u32 v86, s48, v76
    v_add_u32 v87, s48, v77
    ds_read_b128 v[52:55], v75
    s_waitcnt lgkmcnt(3)
    v_mfma_f32_32x32x16_bf16 v[0:15], v[56:59], v[48:51], v[0:15]
    ds_read_b64_tr_b16 v[56:57], v78 offset:15480
    ds_read_b64_tr_b16 v[58:59], v78 offset:16760
    s_waitcnt lgkmcnt(3)
    v_mfma_f32_32x32x16_bf16 v[16:31], v[60:63], v[48:51], v[16:31]
    ds_read_b64_tr_b16 v[60:61], v79 offset:15360
    ds_read_b64_tr_b16 v[62:63], v79 offset:16640
    v_add_u32 v75, s47, v71
    s_waitcnt lgkmcnt(0)
    s_barrier
    ds_read_b128 v[48:51], v72
    s_waitcnt lgkmcnt(3)
    v_mfma_f32_32x32x16_bf16 v[0:15], v[56:59], v[52:55], v[0:15]
    ds_read_b64_tr_b16 v[56:57], v86 offset:120
    ds_read_b64_tr_b16 v[58:59], v86 offset:1400
    s_waitcnt lgkmcnt(3)
    v_mfma_f32_32x32x16_bf16 v[16:31], v[60:63], v[52:55], v[16:31]
    ds_read_b64_tr_b16 v[60:61], v87 offset:0
    ds_read_b64_tr_b16 v[62:63], v87 offset:1280
    v_mov_b32 v78, v86
    v_mov_b32 v79, v87
    s_add_u32 s41, s41, 1
    s_cmp_lt_u32 s41, 10
    s_cbranch_scc1 L_proj_loop_qk1
    s_and_b32 s56, s57, 1
    s_lshl_b32 s39, s37, 1
    s_lshr_b32 s40, s57, 1
    s_add_u32 s39, s39, s40
    s_lshr_b32 s40, s38, 2
    s_cmp_eq_u32 s40, 1
    s_mov_b32 s54, 163840
    s_cselect_b32 s54, s54, 81920
    s_mov_b32 s53, 5120
    s_cselect_b32 s53, s53, 2560
    s_mov_b32 s40, 0
    s_cselect_b32 s40, s40, 6291456
    s_cselect_b32 s55, 1.0, 0x3ea52b5c
    s_mul_i32 s52, s39, s53
    s_add_u32 s52, s52, s40
    s_and_b32 s39, s38, 3
    s_lshl_b32 s39, s39, 3
    s_cmp_ge_u32 s38, 12
    s_cselect_b32 s40, 32, 0
    s_add_u32 s39, s39, s40
    s_mul_i32 s39, s39, s54
    s_add_u32 s52, s52, s39
    s_lshl_b32 s39, s56, 3
    s_add_u32 s53, s52, s39
    s_lshl_b32 s39, s56, 10
    s_add_u32 s52, s52, s39
    v_lshlrev_b32 v88, 4, v123
    v_and_b32 v124, 31, v123
    v_lshlrev_b32 v124, 4, v124
    v_lshrrev_b32 v125, 5, v123
    v_mul_u32_u24 v125, s54, v125
    v_add_u32 v89, v124, v125
    s_cmp_lg_u32 s54, 163840
    s_cbranch_scc1 L_proj_qkhot1
    s_cmp_lt_u32 s37, 2
    s_cbranch_scc1 L_proj_qkhot1
    v_mul_f32 v0, s55, v0
    v_mul_f32 v1, s55, v1
    v_mul_f32 v2, s55, v2
    v_mul_f32 v3, s55, v3
    v_mul_f32 v4, s55, v4
    v_mul_f32 v5, s55, v5
    v_mul_f32 v6, s55, v6
    v_mul_f32 v7, s55, v7
    v_cvt_pk_bf16_f32 v0, v0, v1
    v_cvt_pk_bf16_f32 v1, v2, v3
    v_cvt_pk_bf16_f32 v2, v4, v5
    v_cvt_pk_bf16_f32 v3, v6, v7
    s_mul_i32 s39, s54, 3
    s_add_u32 s39, s39, s52
    buffer_store_dwordx4 v[0:3], v88, s[28:31], s39 offen nt
    v_mul_f32 v8, s55, v8
    v_mul_f32 v9, s55, v9
    v_mul_f32 v10, s55, v10
    v_mul_f32 v11, s55, v11
    v_mul_f32 v12, s55, v12
    v_mul_f32 v13, s55, v13
    v_mul_f32 v14, s55, v14
    v_mul_f32 v15, s55, v15
    v_cvt_pk_bf16_f32 v8, v8, v9
    v_cvt_pk_bf16_f32 v9, v10, v11
    v_cvt_pk_bf16_f32 v10, v12, v13
    v_cvt_pk_bf16_f32 v11, v14, v15
    s_mul_i32 s39, s54, 7
    s_add_u32 s39, s39, s52
    buffer_store_dwordx4 v[8:11], v88, s[28:31], s39 offen nt
    v_mul_f32 v16, s55, v16
    v_mul_f32 v17, s55, v17
    v_mul_f32 v18, s55, v18
    v_mul_f32 v19, s55, v19
    v_mul_f32 v20, s55, v20
    v_mul_f32 v21, s55, v21
    v_mul_f32 v22, s55, v22
    v_mul_f32 v23, s55, v23
    v_cvt_pk_bf16_f32 v16, v16, v17
    v_cvt_pk_bf16_f32 v17, v18, v19
    v_cvt_pk_bf16_f32 v18, v20, v21
    v_cvt_pk_bf16_f32 v19, v22, v23
    s_mul_i32 s39, s54, 0
    s_add_u32 s39, s39, s53
    buffer_store_dwordx2 v[16:17], v89, s[28:31], s39 offen offset:2048 nt
    s_mul_i32 s39, s54, 2
    s_add_u32 s39, s39, s53
    buffer_store_dwordx2 v[18:19], v89, s[28:31], s39 offen offset:2048 nt
    v_mul_f32 v24, s55, v24
    v_mul_f32 v25, s55, v25
    v_mul_f32 v26, s55, v26
    v_mul_f32 v27, s55, v27
    v_mul_f32 v28, s55, v28
    v_mul_f32 v29, s55, v29
    v_mul_f32 v30, s55, v30
    v_mul_f32 v31, s55, v31
    v_cvt_pk_bf16_f32 v24, v24, v25
    v_cvt_pk_bf16_f32 v25, v26, v27
    v_cvt_pk_bf16_f32 v26, v28, v29
    v_cvt_pk_bf16_f32 v27, v30, v31
    s_mul_i32 s39, s54, 4
    s_add_u32 s39, s39, s53
    buffer_store_dwordx2 v[24:25], v89, s[28:31], s39 offen offset:2048 nt
    s_mul_i32 s39, s54, 6
    s_add_u32 s39, s39, s53
    buffer_store_dwordx2 v[26:27], v89, s[28:31], s39 offen offset:2048 nt
    s_endpgm
L_proj_qkhot1:
    v_mul_f32 v0, s55, v0
    v_mul_f32 v1, s55, v1
    v_mul_f32 v2, s55, v2
    v_mul_f32 v3, s55, v3
    v_mul_f32 v4, s55, v4
    v_mul_f32 v5, s55, v5
    v_mul_f32 v6, s55, v6
    v_mul_f32 v7, s55, v7
    v_cvt_pk_bf16_f32 v0, v0, v1
    v_cvt_pk_bf16_f32 v1, v2, v3
    v_cvt_pk_bf16_f32 v2, v4, v5
    v_cvt_pk_bf16_f32 v3, v6, v7
    s_mul_i32 s39, s54, 3
    s_add_u32 s39, s39, s52
    buffer_store_dwordx4 v[0:3], v88, s[28:31], s39 offen
    v_mul_f32 v8, s55, v8
    v_mul_f32 v9, s55, v9
    v_mul_f32 v10, s55, v10
    v_mul_f32 v11, s55, v11
    v_mul_f32 v12, s55, v12
    v_mul_f32 v13, s55, v13
    v_mul_f32 v14, s55, v14
    v_mul_f32 v15, s55, v15
    v_cvt_pk_bf16_f32 v8, v8, v9
    v_cvt_pk_bf16_f32 v9, v10, v11
    v_cvt_pk_bf16_f32 v10, v12, v13
    v_cvt_pk_bf16_f32 v11, v14, v15
    s_mul_i32 s39, s54, 7
    s_add_u32 s39, s39, s52
    buffer_store_dwordx4 v[8:11], v88, s[28:31], s39 offen
    v_mul_f32 v16, s55, v16
    v_mul_f32 v17, s55, v17
    v_mul_f32 v18, s55, v18
    v_mul_f32 v19, s55, v19
    v_mul_f32 v20, s55, v20
    v_mul_f32 v21, s55, v21
    v_mul_f32 v22, s55, v22
    v_mul_f32 v23, s55, v23
    v_cvt_pk_bf16_f32 v16, v16, v17
    v_cvt_pk_bf16_f32 v17, v18, v19
    v_cvt_pk_bf16_f32 v18, v20, v21
    v_cvt_pk_bf16_f32 v19, v22, v23
    s_mul_i32 s39, s54, 0
    s_add_u32 s39, s39, s53
    buffer_store_dwordx2 v[16:17], v89, s[28:31], s39 offen offset:2048
    s_mul_i32 s39, s54, 2
    s_add_u32 s39, s39, s53
    buffer_store_dwordx2 v[18:19], v89, s[28:31], s39 offen offset:2048
    v_mul_f32 v24, s55, v24
    v_mul_f32 v25, s55, v25
    v_mul_f32 v26, s55, v26
    v_mul_f32 v27, s55, v27
    v_mul_f32 v28, s55, v28
    v_mul_f32 v29, s55, v29
    v_mul_f32 v30, s55, v30
    v_mul_f32 v31, s55, v31
    v_cvt_pk_bf16_f32 v24, v24, v25
    v_cvt_pk_bf16_f32 v25, v26, v27
    v_cvt_pk_bf16_f32 v26, v28, v29
    v_cvt_pk_bf16_f32 v27, v30, v31
    s_mul_i32 s39, s54, 4
    s_add_u32 s39, s39, s53
    buffer_store_dwordx2 v[24:25], v89, s[28:31], s39 offen offset:2048
    s_mul_i32 s39, s54, 6
    s_add_u32 s39, s39, s53
    buffer_store_dwordx2 v[26:27], v89, s[28:31], s39 offen offset:2048
    s_endpgm
L_proj_loop_v1:
    ds_read_b128 v[52:55], v73
    s_waitcnt lgkmcnt(3)
    v_mfma_f32_32x32x16_bf16 v[0:15], v[48:51], v[56:59], v[0:15]
    ds_read_b64_tr_b16 v[56:57], v78 offset:5240
    ds_read_b64_tr_b16 v[58:59], v78 offset:6520
    s_waitcnt lgkmcnt(3)
    v_mfma_f32_32x32x16_bf16 v[16:31], v[48:51], v[60:63], v[16:31]
    ds_read_b64_tr_b16 v[60:61], v79 offset:5120
    ds_read_b64_tr_b16 v[62:63], v79 offset:6400
    s_add_u32 s47, s47, 16384
    s_and_b32 s47, s47, 0xffff
    s_add_u32 s48, s48, 20480
    s_cmp_ge_u32 s48, 81920
    s_cselect_b32 s48, 0, s48
    v_add_u32 v72, s47, v68
    v_add_u32 v73, s47, v69
    ds_read_b128 v[48:51], v74
    s_waitcnt lgkmcnt(3)
    v_mfma_f32_32x32x16_bf16 v[0:15], v[52:55], v[56:59], v[0:15]
    ds_read_b64_tr_b16 v[56:57], v78 offset:10360
    ds_read_b64_tr_b16 v[58:59], v78 offset:11640
    s_waitcnt lgkmcnt(3)
    v_mfma_f32_32x32x16_bf16 v[16:31], v[52:55], v[60:63], v[16:31]
    ds_read_b64_tr_b16 v[60:61], v79 offset:10240
    ds_read_b64_tr_b16 v[62:63], v79 offset:11520
    v_add_u32 v74, s47, v70
    v_add_u32 v86, s48, v76
    v_add_u32 v87, s48, v77
    ds_read_b128 v[52:55], v75
    s_waitcnt lgkmcnt(3)
    v_mfma_f32_32x32x16_bf16 v[0:15], v[48:51], v[56:59], v[0:15]
    ds_read_b64_tr_b16 v[56:57], v78 offset:15480
    ds_read_b64_tr_b16 v[58:59], v78 offset:16760
    s_waitcnt lgkmcnt(3)
    v_mfma_f32_32x32x16_bf16 v[16:31], v[48:51], v[60:63], v[16:31]
    ds_read_b64_tr_b16 v[60:61], v79 offset:15360
    ds_read_b64_tr_b16 v[62:63], v79 offset:16640
    v_add_u32 v75, s47, v71
    s_waitcnt lgkmcnt(0)
    s_barrier
    ds_read_b128 v[48:51], v72
    s_waitcnt lgkmcnt(3)
    v_mfma_f32_32x32x16_bf16 v[0:15], v[52:55], v[56:59], v[0:15]
    ds_read_b64_tr_b16 v[56:57], v86 offset:120
    ds_read_b64_tr_b16 v[58:59], v86 offset:1400
    s_waitcnt lgkmcnt(3)
    v_mfma_f32_32x32x16_bf16 v[16:31], v[52:55], v[60:63], v[16:31]
    ds_read_b64_tr_b16 v[60:61], v87 offset:0
    ds_read_b64_tr_b16 v[62:63], v87 offset:1280
    v_mov_b32 v78, v86
    v_mov_b32 v79, v87
    s_add_u32 s41, s41, 1
    s_cmp_lt_u32 s41, 10
    s_cbranch_scc1 L_proj_loop_v1
    s_and_b32 s56, s57, 1
    s_lshl_b32 s39, s37, 1
    s_lshr_b32 s40, s57, 1
    s_add_u32 s39, s39, s40
    s_mul_i32 s52, s39, 5120
    s_mul_i32 s39, s56, 1280
    s_add_u32 s52, s52, s39
    s_and_b32 s39, s38, 3
    s_mul_i32 s39, s39, 1310720
    s_add_u32 s52, s52, s39
    s_add_u32 s52, s52, 2560
    s_mov_b32 s39, 163840
    v_lshrrev_b32 v125, 5, v123
    v_mul_u32_u24 v127, 320, v125
    v_and_b32 v124, 3, v123
    v_lshl_add_u32 v127, v124, 4, v127
    v_bfe_u32 v124, v123, 4, 1
    v_lshlrev_b32 v124, 2, v124
    v_mul_u32_u24 v124, s39, v124
    v_add_u32 v88, v127, v124
    v_bfe_u32 v124, v123, 2, 1
    v_lshl_add_u32 v88, v124, 7, v88
    v_bfe_u32 v124, v123, 3, 1
    v_lshl_add_u32 v88, v124, 6, v88
    v_bfe_u32 v124, v123, 2, 3
    v_mul_u32_u24 v124, s39, v124
    v_add3_u32 v89, v127, v124, 0
    s_cmp_lt_u32 s37, 2
    s_cbranch_scc1 L_proj_vhot1
    v_cvt_pk_bf16_f32 v0, v0, v1
    v_cvt_pk_bf16_f32 v1, v2, v3
    v_cvt_pk_bf16_f32 v2, v4, v5
    v_cvt_pk_bf16_f32 v3, v6, v7
    s_add_u32 s39, s52, 491520
    buffer_store_dwordx4 v[0:3], v88, s[28:31], s39 offen offset:0 nt
    v_cvt_pk_bf16_f32 v8, v8, v9
    v_cvt_pk_bf16_f32 v9, v10, v11
    v_cvt_pk_bf16_f32 v10, v12, v13
    v_cvt_pk_bf16_f32 v11, v14, v15
    s_add_u32 s39, s52, 491520
    buffer_store_dwordx4 v[8:11], v88, s[28:31], s39 offen offset:640 nt
    v_cvt_pk_bf16_f32 v16, v16, v17
    v_cvt_pk_bf16_f32 v17, v18, v19
    v_cvt_pk_bf16_f32 v18, v20, v21
    v_cvt_pk_bf16_f32 v19, v22, v23
    buffer_store_dwordx4 v[16:19], v89, s[28:31], s52 offen offset:256 nt
    v_cvt_pk_bf16_f32 v24, v24, v25
    v_cvt_pk_bf16_f32 v25, v26, v27
    v_cvt_pk_bf16_f32 v26, v28, v29
    v_cvt_pk_bf16_f32 v27, v30, v31
    buffer_store_dwordx4 v[24:27], v89, s[28:31], s52 offen offset:896 nt
    s_endpgm
L_proj_vhot1:
    v_cvt_pk_bf16_f32 v0, v0, v1
    v_cvt_pk_bf16_f32 v1, v2, v3
    v_cvt_pk_bf16_f32 v2, v4, v5
    v_cvt_pk_bf16_f32 v3, v6, v7
    s_add_u32 s39, s52, 491520
    buffer_store_dwordx4 v[0:3], v88, s[28:31], s39 offen offset:0
    v_cvt_pk_bf16_f32 v8, v8, v9
    v_cvt_pk_bf16_f32 v9, v10, v11
    v_cvt_pk_bf16_f32 v10, v12, v13
    v_cvt_pk_bf16_f32 v11, v14, v15
    s_add_u32 s39, s52, 491520
    buffer_store_dwordx4 v[8:11], v88, s[28:31], s39 offen offset:640
    v_cvt_pk_bf16_f32 v16, v16, v17
    v_cvt_pk_bf16_f32 v17, v18, v19
    v_cvt_pk_bf16_f32 v18, v20, v21
    v_cvt_pk_bf16_f32 v19, v22, v23
    buffer_store_dwordx4 v[16:19], v89, s[28:31], s52 offen offset:256
    v_cvt_pk_bf16_f32 v24, v24, v25
    v_cvt_pk_bf16_f32 v25, v26, v27
    v_cvt_pk_bf16_f32 v26, v28, v29
    v_cvt_pk_bf16_f32 v27, v30, v31
    buffer_store_dwordx4 v[24:27], v89, s[28:31], s52 offen offset:896
    s_endpgm
L_proj_extra:
    s_and_b32 s56, s38, 1
    s_cmp_eq_u32 s56, 0
    s_cselect_b32 s24, s10, s12
    s_cselect_b32 s39, s11, s13
    s_and_b32 s25, s39, 0xffff
    s_mov_b32 s26, 25600
    v_lshlrev_b32 v12, 4, v123
    s_mov_b32 s44, 0
    s_mov_b32 s45, 147456
    s_mov_b32 m0, 157952
    s_nop 0
    buffer_load_dwordx4 v12, s[32:35], 0 offen lds
    buffer_load_dwordx4 v12, s[32:35], 0 offen offset:1024 lds
    s_mov_b32 m0, s45
    s_nop 0
    buffer_load_dwordx4 v12, s[24:27], s44 offen lds
    buffer_load_dwordx4 v12, s[24:27], s44 offen offset:1024 lds
    s_mov_b32 exec_hi, 0
    buffer_load_dwordx4 v12, s[24:27], s44 offen offset:2048 lds
    s_mov_b64 exec, -1
    s_add_u32 s44, s44, 2560
    s_add_u32 s45, s45, 2560
    s_cmp_ge_u32 s45, 157696
    s_cselect_b32 s45, 147456, s45
    s_mov_b32 m0, s45
    s_nop 0
    buffer_load_dwordx4 v12, s[24:27], s44 offen lds
    buffer_load_dwordx4 v12, s[24:27], s44 offen offset:1024 lds
    s_mov_b32 exec_hi, 0
    buffer_load_dwordx4 v12, s[24:27], s44 offen offset:2048 lds
    s_mov_b64 exec, -1
    s_add_u32 s44, s44, 2560
    s_add_u32 s45, s45, 2560
    s_cmp_ge_u32 s45, 157696
    s_cselect_b32 s45, 147456, s45
    s_mov_b32 m0, s45
    s_nop 0
    buffer_load_dwordx4 v12, s[24:27], s44 offen lds
    buffer_load_dwordx4 v12, s[24:27], s44 offen offset:1024 lds
    s_mov_b32 exec_hi, 0
    buffer_load_dwordx4 v12, s[24:27], s44 offen offset:2048 lds
    s_mov_b64 exec, -1
    s_add_u32 s44, s44, 2560
    s_add_u32 s45, s45, 2560
    s_cmp_ge_u32 s45, 157696
    s_cselect_b32 s45, 147456, s45
    s_mov_b32 m0, s45
    s_nop 0
    buffer_load_dwordx4 v12, s[24:27], s44 offen lds
    buffer_load_dwordx4 v12, s[24:27], s44 offen offset:1024 lds
    s_mov_b32 exec_hi, 0
    buffer_load_dwordx4 v12, s[24:27], s44 offen offset:2048 lds
    s_mov_b64 exec, -1
    s_add_u32 s44, s44, 2560
    s_add_u32 s45, s45, 2560
    s_cmp_ge_u32 s45, 157696
    s_cselect_b32 s45, 147456, s45
    s_lshr_b32 s39, s38, 1
    s_lshl_b32 s39, s39, 4
    v_and_b32 v124, 15, v123
    v_add_u32 v124, s39, v124
    v_bfe_u32 v125, v124, 1, 3
    v_lshrrev_b32 v126, 4, v123
    v_xor_b32 v125, v125, v126
    v_lshlrev_b32 v125, 4, v125
    v_lshl_add_u32 v13, v124, 7, v125
    v_xor_b32 v14, 64, v13
    v_bfe_u32 v125, v123, 2, 2
    v_lshl_add_u32 v125, v126, 3, v125
    v_mul_u32_u24 v125, 40, v125
    v_and_b32 v127, 3, v123
    v_lshl_add_u32 v125, v127, 3, v125
    v_add_u32 v15, 147456, v125
    v_mov_b32 v0, 0
    v_mov_b32 v1, 0
    v_mov_b32 v2, 0
    v_mov_b32 v3, 0
    v_mov_b32 v4, 0
    v_mov_b32 v5, 0
    v_mov_b32 v6, 0
    v_mov_b32 v7, 0
    v_mov_b32 v8, 0
    v_mov_b32 v9, 0
    v_mov_b32 v10, 0
    v_mov_b32 v11, 0
    s_mov_b32 s47, 0
    s_mov_b32 s48, 0
    s_waitcnt vmcnt(9)
    s_barrier
    v_lshrrev_b32 v24, 4, v123
    v_lshlrev_b32 v24, 4, v24
    v_add_u32 v24, 157952, v24
    s_cmp_eq_u32 s56, 0
    s_cbranch_scc0 L_proj_ex_v
    v_add_u32 v120, s47, v13
    v_add_u32 v121, s47, v14
    v_add_u32 v122, s48, v15
    ds_read_b128 v[96:99], v120
    ds_read_b128 v[16:19], v24 offset:0
    ds_read_b64_tr_b16 v[104:105], v122 offset:0
    ds_read_b64_tr_b16 v[106:107], v122 offset:160
    ds_read_b64_tr_b16 v[108:109], v122 offset:32
    ds_read_b64_tr_b16 v[110:111], v122 offset:192
    ds_read_b128 v[100:103], v121
    ds_read_b128 v[20:23], v24 offset:64
    ds_read_b64_tr_b16 v[112:113], v122 offset:1280
    ds_read_b64_tr_b16 v[114:115], v122 offset:1440
    ds_read_b64_tr_b16 v[116:117], v122 offset:1312
    ds_read_b64_tr_b16 v[118:119], v122 offset:1472
    s_waitcnt lgkmcnt(0)
    s_waitcnt vmcnt(6)
    s_barrier
    v_mfma_f32_16x16x32_bf16 v[0:3], v[104:107], v[96:99], v[0:3]
    v_mfma_f32_16x16x32_bf16 v[4:7], v[108:111], v[96:99], v[4:7]
    v_mfma_f32_16x16x32_bf16 v[8:11], v[16:19], v[96:99], v[8:11]
    v_mfma_f32_16x16x32_bf16 v[0:3], v[112:115], v[100:103], v[0:3]
    v_mfma_f32_16x16x32_bf16 v[4:7], v[116:119], v[100:103], v[4:7]
    v_mfma_f32_16x16x32_bf16 v[8:11], v[20:23], v[100:103], v[8:11]
    s_mov_b32 m0, s45
    s_nop 0
    buffer_load_dwordx4 v12, s[24:27], s44 offen lds
    buffer_load_dwordx4 v12, s[24:27], s44 offen offset:1024 lds
    s_mov_b32 exec_hi, 0
    buffer_load_dwordx4 v12, s[24:27], s44 offen offset:2048 lds
    s_mov_b64 exec, -1
    s_add_u32 s44, s44, 2560
    s_add_u32 s45, s45, 2560
    s_cmp_ge_u32 s45, 157696
    s_cselect_b32 s45, 147456, s45
    s_add_u32 s47, s47, 16384
    s_and_b32 s47, s47, 0xffff
    s_add_u32 s48, s48, 2560
    s_cmp_ge_u32 s48, 10240
    s_cselect_b32 s48, 0, s48
    v_add_u32 v120, s47, v13
    v_add_u32 v121, s47, v14
    v_add_u32 v122, s48, v15
    ds_read_b128 v[96:99], v120
    ds_read_b128 v[16:19], v24 offset:128
    ds_read_b64_tr_b16 v[104:105], v122 offset:0
    ds_read_b64_tr_b16 v[106:107], v122 offset:160
    ds_read_b64_tr_b16 v[108:109], v122 offset:32
    ds_read_b64_tr_b16 v[110:111], v122 offset:192
    ds_read_b128 v[100:103], v121
    ds_read_b128 v[20:23], v24 offset:192
    ds_read_b64_tr_b16 v[112:113], v122 offset:1280
    ds_read_b64_tr_b16 v[114:115], v122 offset:1440
    ds_read_b64_tr_b16 v[116:117], v122 offset:1312
    ds_read_b64_tr_b16 v[118:119], v122 offset:1472
    s_waitcnt lgkmcnt(0)
    s_waitcnt vmcnt(6)
    s_barrier
    v_mfma_f32_16x16x32_bf16 v[0:3], v[104:107], v[96:99], v[0:3]
    v_mfma_f32_16x16x32_bf16 v[4:7], v[108:111], v[96:99], v[4:7]
    v_mfma_f32_16x16x32_bf16 v[8:11], v[16:19], v[96:99], v[8:11]
    v_mfma_f32_16x16x32_bf16 v[0:3], v[112:115], v[100:103], v[0:3]
    v_mfma_f32_16x16x32_bf16 v[4:7], v[116:119], v[100:103], v[4:7]
    v_mfma_f32_16x16x32_bf16 v[8:11], v[20:23], v[100:103], v[8:11]
    s_mov_b32 m0, s45
    s_nop 0
    buffer_load_dwordx4 v12, s[24:27], s44 offen lds
    buffer_load_dwordx4 v12, s[24:27], s44 offen offset:1024 lds
    s_mov_b32 exec_hi, 0
    buffer_load_dwordx4 v12, s[24:27], s44 offen offset:2048 lds
    s_mov_b64 exec, -1
    s_add_u32 s44, s44, 2560
    s_add_u32 s45, s45, 2560
    s_cmp_ge_u32 s45, 157696
    s_cselect_b32 s45, 147456, s45
    s_add_u32 s47, s47, 16384
    s_and_b32 s47, s47, 0xffff
    s_add_u32 s48, s48, 2560
    s_cmp_ge_u32 s48, 10240
    s_cselect_b32 s48, 0, s48
    v_add_u32 v120, s47, v13
    v_add_u32 v121, s47, v14
    v_add_u32 v122, s48, v15
    ds_read_b128 v[96:99], v120
    ds_read_b128 v[16:19], v24 offset:256
    ds_read_b64_tr_b16 v[104:105], v122 offset:0
    ds_read_b64_tr_b16 v[106:107], v122 offset:160
    ds_read_b64_tr_b16 v[108:109], v122 offset:32
    ds_read_b64_tr_b16 v[110:111], v122 offset:192
    ds_read_b128 v[100:103], v121
    ds_read_b128 v[20:23], v24 offset:320
    ds_read_b64_tr_b16 v[112:113], v122 offset:1280
    ds_read_b64_tr_b16 v[114:115], v122 offset:1440
    ds_read_b64_tr_b16 v[116:117], v122 offset:1312
    ds_read_b64_tr_b16 v[118:119], v122 offset:1472
    s_waitcnt lgkmcnt(0)
    s_waitcnt vmcnt(6)
    s_barrier
    v_mfma_f32_16x16x32_bf16 v[0:3], v[104:107], v[96:99], v[0:3]
    v_mfma_f32_16x16x32_bf16 v[4:7], v[108:111], v[96:99], v[4:7]
    v_mfma_f32_16x16x32_bf16 v[8:11], v[16:19], v[96:99], v[8:11]
    v_mfma_f32_16x16x32_bf16 v[0:3], v[112:115], v[100:103], v[0:3]
    v_mfma_f32_16x16x32_bf16 v[4:7], v[116:119], v[100:103], v[4:7]
    v_mfma_f32_16x16x32_bf16 v[8:11], v[20:23], v[100:103], v[8:11]
    s_mov_b32 m0, s45
    s_nop 0
    buffer_load_dwordx4 v12, s[24:27], s44 offen lds
    buffer_load_dwordx4 v12, s[24:27], s44 offen offset:1024 lds
    s_mov_b32 exec_hi, 0
    buffer_load_dwordx4 v12, s[24:27], s44 offen offset:2048 lds
    s_mov_b64 exec, -1
    s_add_u32 s44, s44, 2560
    s_add_u32 s45, s45, 2560
    s_cmp_ge_u32 s45, 157696
    s_cselect_b32 s45, 147456, s45
    s_add_u32 s47, s47, 16384
    s_and_b32 s47, s47, 0xffff
    s_add_u32 s48, s48, 2560
    s_cmp_ge_u32 s48, 10240
    s_cselect_b32 s48, 0, s48
    v_add_u32 v120, s47, v13
    v_add_u32 v121, s47, v14
    v_add_u32 v122, s48, v15
    ds_read_b128 v[96:99], v120
    ds_read_b128 v[16:19], v24 offset:384
    ds_read_b64_tr_b16 v[104:105], v122 offset:0
    ds_read_b64_tr_b16 v[106:107], v122 offset:160
    ds_read_b64_tr_b16 v[108:109], v122 offset:32
    ds_read_b64_tr_b16 v[110:111], v122 offset:192
    ds_read_b128 v[100:103], v121
    ds_read_b128 v[20:23], v24 offset:448
    ds_read_b64_tr_b16 v[112:113], v122 offset:1280
    ds_read_b64_tr_b16 v[114:115], v122 offset:1440
    ds_read_b64_tr_b16 v[116:117], v122 offset:1312
    ds_read_b64_tr_b16 v[118:119], v122 offset:1472
    s_waitcnt lgkmcnt(0)
    s_waitcnt vmcnt(6)
    s_barrier
    v_mfma_f32_16x16x32_bf16 v[0:3], v[104:107], v[96:99], v[0:3]
    v_mfma_f32_16x16x32_bf16 v[4:7], v[108:111], v[96:99], v[4:7]
    v_mfma_f32_16x16x32_bf16 v[8:11], v[16:19], v[96:99], v[8:11]
    v_mfma_f32_16x16x32_bf16 v[0:3], v[112:115], v[100:103], v[0:3]
    v_mfma_f32_16x16x32_bf16 v[4:7], v[116:119], v[100:103], v[4:7]
    v_mfma_f32_16x16x32_bf16 v[8:11], v[20:23], v[100:103], v[8:11]
    s_mov_b32 m0, s45
    s_nop 0
    buffer_load_dwordx4 v12, s[24:27], s44 offen lds
    buffer_load_dwordx4 v12, s[24:27], s44 offen offset:1024 lds
    s_mov_b32 exec_hi, 0
    buffer_load_dwordx4 v12, s[24:27], s44 offen offset:2048 lds
    s_mov_b64 exec, -1
    s_add_u32 s44, s44, 2560
    s_add_u32 s45, s45, 2560
    s_cmp_ge_u32 s45, 157696
    s_cselect_b32 s45, 147456, s45
    s_add_u32 s47, s47, 16384
    s_and_b32 s47, s47, 0xffff
    s_add_u32 s48, s48, 2560
    s_cmp_ge_u32 s48, 10240
    s_cselect_b32 s48, 0, s48
    v_add_u32 v120, s47, v13
    v_add_u32 v121, s47, v14
    v_add_u32 v122, s48, v15
    ds_read_b128 v[96:99], v120
    ds_read_b128 v[16:19], v24 offset:512
    ds_read_b64_tr_b16 v[104:105], v122 offset:0
    ds_read_b64_tr_b16 v[106:107], v122 offset:160
    ds_read_b64_tr_b16 v[108:109], v122 offset:32
    ds_read_b64_tr_b16 v[110:111], v122 offset:192
    ds_read_b128 v[100:103], v121
    ds_read_b128 v[20:23], v24 offset:576
    ds_read_b64_tr_b16 v[112:113], v122 offset:1280
    ds_read_b64_tr_b16 v[114:115], v122 offset:1440
    ds_read_b64_tr_b16 v[116:117], v122 offset:1312
    ds_read_b64_tr_b16 v[118:119], v122 offset:1472
    s_waitcnt lgkmcnt(0)
    s_waitcnt vmcnt(6)
    s_barrier
    v_mfma_f32_16x16x32_bf16 v[0:3], v[104:107], v[96:99], v[0:3]
    v_mfma_f32_16x16x32_bf16 v[4:7], v[108:111], v[96:99], v[4:7]
    v_mfma_f32_16x16x32_bf16 v[8:11], v[16:19], v[96:99], v[8:11]
    v_mfma_f32_16x16x32_bf16 v[0:3], v[112:115], v[100:103], v[0:3]
    v_mfma_f32_16x16x32_bf16 v[4:7], v[116:119], v[100:103], v[4:7]
    v_mfma_f32_16x16x32_bf16 v[8:11], v[20:23], v[100:103], v[8:11]
    s_mov_b32 m0, s45
    s_nop 0
    buffer_load_dwordx4 v12, s[24:27], s44 offen lds
    buffer_load_dwordx4 v12, s[24:27], s44 offen offset:1024 lds
    s_mov_b32 exec_hi, 0
    buffer_load_dwordx4 v12, s[24:27], s44 offen offset:2048 lds
    s_mov_b64 exec, -1
    s_add_u32 s44, s44, 2560
    s_add_u32 s45, s45, 2560
    s_cmp_ge_u32 s45, 157696
    s_cselect_b32 s45, 147456, s45
    s_add_u32 s47, s47, 16384
    s_and_b32 s47, s47, 0xffff
    s_add_u32 s48, s48, 2560
    s_cmp_ge_u32 s48, 10240
    s_cselect_b32 s48, 0, s48
    v_add_u32 v120, s47, v13
    v_add_u32 v121, s47, v14
    v_add_u32 v122, s48, v15
    ds_read_b128 v[96:99], v120
    ds_read_b128 v[16:19], v24 offset:640
    ds_read_b64_tr_b16 v[104:105], v122 offset:0
    ds_read_b64_tr_b16 v[106:107], v122 offset:160
    ds_read_b64_tr_b16 v[108:109], v122 offset:32
    ds_read_b64_tr_b16 v[110:111], v122 offset:192
    ds_read_b128 v[100:103], v121
    ds_read_b128 v[20:23], v24 offset:704
    ds_read_b64_tr_b16 v[112:113], v122 offset:1280
    ds_read_b64_tr_b16 v[114:115], v122 offset:1440
    ds_read_b64_tr_b16 v[116:117], v122 offset:1312
    ds_read_b64_tr_b16 v[118:119], v122 offset:1472
    s_waitcnt lgkmcnt(0)
    s_waitcnt vmcnt(6)
    s_barrier
    v_mfma_f32_16x16x32_bf16 v[0:3], v[104:107], v[96:99], v[0:3]
    v_mfma_f32_16x16x32_bf16 v[4:7], v[108:111], v[96:99], v[4:7]
    v_mfma_f32_16x16x32_bf16 v[8:11], v[16:19], v[96:99], v[8:11]
    v_mfma_f32_16x16x32_bf16 v[0:3], v[112:115], v[100:103], v[0:3]
    v_mfma_f32_16x16x32_bf16 v[4:7], v[116:119], v[100:103], v[4:7]
    v_mfma_f32_16x16x32_bf16 v[8:11], v[20:23], v[100:103], v[8:11]
    s_mov_b32 m0, s45
    s_nop 0
    buffer_load_dwordx4 v12, s[24:27], s44 offen lds
    buffer_load_dwordx4 v12, s[24:27], s44 offen offset:1024 lds
    s_mov_b32 exec_hi, 0
    buffer_load_dwordx4 v12, s[24:27], s44 offen offset:2048 lds
    s_mov_b64 exec, -1
    s_add_u32 s44, s44, 2560
    s_add_u32 s45, s45, 2560
    s_cmp_ge_u32 s45, 157696
    s_cselect_b32 s45, 147456, s45
    s_add_u32 s47, s47, 16384
    s_and_b32 s47, s47, 0xffff
    s_add_u32 s48, s48, 2560
    s_cmp_ge_u32 s48, 10240
    s_cselect_b32 s48, 0, s48
    v_add_u32 v120, s47, v13
    v_add_u32 v121, s47, v14
    v_add_u32 v122, s48, v15
    ds_read_b128 v[96:99], v120
    ds_read_b128 v[16:19], v24 offset:768
    ds_read_b64_tr_b16 v[104:105], v122 offset:0
    ds_read_b64_tr_b16 v[106:107], v122 offset:160
    ds_read_b64_tr_b16 v[108:109], v122 offset:32
    ds_read_b64_tr_b16 v[110:111], v122 offset:192
    ds_read_b128 v[100:103], v121
    ds_read_b128 v[20:23], v24 offset:832
    ds_read_b64_tr_b16 v[112:113], v122 offset:1280
    ds_read_b64_tr_b16 v[114:115], v122 offset:1440
    ds_read_b64_tr_b16 v[116:117], v122 offset:1312
    ds_read_b64_tr_b16 v[118:119], v122 offset:1472
    s_waitcnt lgkmcnt(0)
    s_waitcnt vmcnt(6)
    s_barrier
    v_mfma_f32_16x16x32_bf16 v[0:3], v[104:107], v[96:99], v[0:3]
    v_mfma_f32_16x16x32_bf16 v[4:7], v[108:111], v[96:99], v[4:7]
    v_mfma_f32_16x16x32_bf16 v[8:11], v[16:19], v[96:99], v[8:11]
    v_mfma_f32_16x16x32_bf16 v[0:3], v[112:115], v[100:103], v[0:3]
    v_mfma_f32_16x16x32_bf16 v[4:7], v[116:119], v[100:103], v[4:7]
    v_mfma_f32_16x16x32_bf16 v[8:11], v[20:23], v[100:103], v[8:11]
    s_add_u32 s47, s47, 16384
    s_and_b32 s47, s47, 0xffff
    s_add_u32 s48, s48, 2560
    s_cmp_ge_u32 s48, 10240
    s_cselect_b32 s48, 0, s48
    v_add_u32 v120, s47, v13
    v_add_u32 v121, s47, v14
    v_add_u32 v122, s48, v15
    ds_read_b128 v[96:99], v120
    ds_read_b128 v[16:19], v24 offset:896
    ds_read_b64_tr_b16 v[104:105], v122 offset:0
    ds_read_b64_tr_b16 v[106:107], v122 offset:160
    ds_read_b64_tr_b16 v[108:109], v122 offset:32
    ds_read_b64_tr_b16 v[110:111], v122 offset:192
    ds_read_b128 v[100:103], v121
    ds_read_b128 v[20:23], v24 offset:960
    ds_read_b64_tr_b16 v[112:113], v122 offset:1280
    ds_read_b64_tr_b16 v[114:115], v122 offset:1440
    ds_read_b64_tr_b16 v[116:117], v122 offset:1312
    ds_read_b64_tr_b16 v[118:119], v122 offset:1472
    s_waitcnt lgkmcnt(0)
    s_waitcnt vmcnt(3)
    s_barrier
    v_mfma_f32_16x16x32_bf16 v[0:3], v[104:107], v[96:99], v[0:3]
    v_mfma_f32_16x16x32_bf16 v[4:7], v[108:111], v[96:99], v[4:7]
    v_mfma_f32_16x16x32_bf16 v[8:11], v[16:19], v[96:99], v[8:11]
    v_mfma_f32_16x16x32_bf16 v[0:3], v[112:115], v[100:103], v[0:3]
    v_mfma_f32_16x16x32_bf16 v[4:7], v[116:119], v[100:103], v[4:7]
    v_mfma_f32_16x16x32_bf16 v[8:11], v[20:23], v[100:103], v[8:11]
    s_add_u32 s47, s47, 16384
    s_and_b32 s47, s47, 0xffff
    s_add_u32 s48, s48, 2560
    s_cmp_ge_u32 s48, 10240
    s_cselect_b32 s48, 0, s48
    v_add_u32 v120, s47, v13
    v_add_u32 v121, s47, v14
    v_add_u32 v122, s48, v15
    ds_read_b128 v[96:99], v120
    ds_read_b128 v[16:19], v24 offset:1024
    ds_read_b64_tr_b16 v[104:105], v122 offset:0
    ds_read_b64_tr_b16 v[106:107], v122 offset:160
    ds_read_b64_tr_b16 v[108:109], v122 offset:32
    ds_read_b64_tr_b16 v[110:111], v122 offset:192
    ds_read_b128 v[100:103], v121
    ds_read_b128 v[20:23], v24 offset:1088
    ds_read_b64_tr_b16 v[112:113], v122 offset:1280
    ds_read_b64_tr_b16 v[114:115], v122 offset:1440
    ds_read_b64_tr_b16 v[116:117], v122 offset:1312
    ds_read_b64_tr_b16 v[118:119], v122 offset:1472
    s_waitcnt lgkmcnt(0)
    s_waitcnt vmcnt(0)
    s_barrier
    v_mfma_f32_16x16x32_bf16 v[0:3], v[104:107], v[96:99], v[0:3]
    v_mfma_f32_16x16x32_bf16 v[4:7], v[108:111], v[96:99], v[4:7]
    v_mfma_f32_16x16x32_bf16 v[8:11], v[16:19], v[96:99], v[8:11]
    v_mfma_f32_16x16x32_bf16 v[0:3], v[112:115], v[100:103], v[0:3]
    v_mfma_f32_16x16x32_bf16 v[4:7], v[116:119], v[100:103], v[4:7]
    v_mfma_f32_16x16x32_bf16 v[8:11], v[20:23], v[100:103], v[8:11]
    s_add_u32 s47, s47, 16384
    s_and_b32 s47, s47, 0xffff
    s_add_u32 s48, s48, 2560
    s_cmp_ge_u32 s48, 10240
    s_cselect_b32 s48, 0, s48
    v_add_u32 v120, s47, v13
    v_add_u32 v121, s47, v14
    v_add_u32 v122, s48, v15
    ds_read_b128 v[96:99], v120
    ds_read_b128 v[16:19], v24 offset:1152
    ds_read_b64_tr_b16 v[104:105], v122 offset:0
    ds_read_b64_tr_b16 v[106:107], v122 offset:160
    ds_read_b64_tr_b16 v[108:109], v122 offset:32
    ds_read_b64_tr_b16 v[110:111], v122 offset:192
    ds_read_b128 v[100:103], v121
    ds_read_b128 v[20:23], v24 offset:1216
    ds_read_b64_tr_b16 v[112:113], v122 offset:1280
    ds_read_b64_tr_b16 v[114:115], v122 offset:1440
    ds_read_b64_tr_b16 v[116:117], v122 offset:1312
    ds_read_b64_tr_b16 v[118:119], v122 offset:1472
    s_waitcnt lgkmcnt(0)
    s_waitcnt vmcnt(0)
    s_barrier
    v_mfma_f32_16x16x32_bf16 v[0:3], v[104:107], v[96:99], v[0:3]
    v_mfma_f32_16x16x32_bf16 v[4:7], v[108:111], v[96:99], v[4:7]
    v_mfma_f32_16x16x32_bf16 v[8:11], v[16:19], v[96:99], v[8:11]
    v_mfma_f32_16x16x32_bf16 v[0:3], v[112:115], v[100:103], v[0:3]
    v_mfma_f32_16x16x32_bf16 v[4:7], v[116:119], v[100:103], v[4:7]
    v_mfma_f32_16x16x32_bf16 v[8:11], v[20:23], v[100:103], v[8:11]
    s_add_u32 s47, s47, 16384
    s_and_b32 s47, s47, 0xffff
    s_add_u32 s48, s48, 2560
    s_cmp_ge_u32 s48, 10240
    s_cselect_b32 s48, 0, s48
    s_lshl_b32 s39, s37, 1
    s_lshr_b32 s40, s38, 3
    s_add_u32 s39, s39, s40
    s_mul_i32 s52, s39, 5120
    s_add_u32 s52, s52, 5242880
    s_bfe_u32 s56, s38, 0x10002
    s_bfe_u32 s40, s38, 0x10001
    v_and_b32 v124, 15, v123
    v_lshrrev_b32 v125, 4, v123
    v_cvt_pk_bf16_f32 v0, v0, v1
    v_cvt_pk_bf16_f32 v1, v2, v3
    v_cvt_pk_bf16_f32 v4, v4, v5
    v_cvt_pk_bf16_f32 v5, v6, v7
    s_lshl_b32 s40, s40, 8
    s_add_u32 s52, s52, s40
    v_lshlrev_b32 v124, 4, v124
    v_lshrrev_b32 v126, 1, v125
    v_lshl_add_u32 v126, v126, 9, v124
    v_and_b32 v127, 1, v125
    v_lshl_add_u32 v126, v127, 3, v126
    s_lshl_b32 s39, s56, 10
    s_add_u32 s39, s39, s52
    buffer_store_dwordx2 v[0:1], v126, s[28:31], s39 offen
    s_lshl_b32 s39, s56, 3
    s_add_u32 s39, s39, s52
    v_mul_f32 v8, 0xbfb8aa3b, v8
    v_exp_f32 v8, v8
    s_nop 0
    v_add_f32 v8, 1.0, v8
    v_rcp_f32 v8, v8
    s_mov_b32 exec_lo, 0xffff
    s_mov_b32 exec_hi, 0
    buffer_store_dwordx2 v[4:5], v124, s[28:31], s39 offen offset:2048
    s_lshl_b32 s39, s37, 9
    s_lshr_b32 s40, s38, 1
    s_lshl_b32 s40, s40, 6
    s_add_u32 s39, s39, s40
    s_add_u32 s39, s39, 18874368
    v_lshrrev_b32 v124, 2, v124
    buffer_store_dword v8, v124, s[28:31], s39 offen
    s_endpgm
L_proj_ex_v:
    v_add_u32 v120, s47, v13
    v_add_u32 v121, s47, v14
    v_add_u32 v122, s48, v15
    ds_read_b128 v[96:99], v120
    ds_read_b64_tr_b16 v[104:105], v122 offset:0
    ds_read_b64_tr_b16 v[106:107], v122 offset:160
    ds_read_b64_tr_b16 v[108:109], v122 offset:32
    ds_read_b64_tr_b16 v[110:111], v122 offset:192
    ds_read_b128 v[100:103], v121
    ds_read_b64_tr_b16 v[112:113], v122 offset:1280
    ds_read_b64_tr_b16 v[114:115], v122 offset:1440
    ds_read_b64_tr_b16 v[116:117], v122 offset:1312
    ds_read_b64_tr_b16 v[118:119], v122 offset:1472
    s_waitcnt lgkmcnt(0)
    s_waitcnt vmcnt(6)
    s_barrier
    v_mfma_f32_16x16x32_bf16 v[0:3], v[96:99], v[104:107], v[0:3]
    v_mfma_f32_16x16x32_bf16 v[4:7], v[96:99], v[108:111], v[4:7]
    v_mfma_f32_16x16x32_bf16 v[0:3], v[100:103], v[112:115], v[0:3]
    v_mfma_f32_16x16x32_bf16 v[4:7], v[100:103], v[116:119], v[4:7]
    s_mov_b32 m0, s45
    s_nop 0
    buffer_load_dwordx4 v12, s[24:27], s44 offen lds
    buffer_load_dwordx4 v12, s[24:27], s44 offen offset:1024 lds
    s_mov_b32 exec_hi, 0
    buffer_load_dwordx4 v12, s[24:27], s44 offen offset:2048 lds
    s_mov_b64 exec, -1
    s_add_u32 s44, s44, 2560
    s_add_u32 s45, s45, 2560
    s_cmp_ge_u32 s45, 157696
    s_cselect_b32 s45, 147456, s45
    s_add_u32 s47, s47, 16384
    s_and_b32 s47, s47, 0xffff
    s_add_u32 s48, s48, 2560
    s_cmp_ge_u32 s48, 10240
    s_cselect_b32 s48, 0, s48
    v_add_u32 v120, s47, v13
    v_add_u32 v121, s47, v14
    v_add_u32 v122, s48, v15
    ds_read_b128 v[96:99], v120
    ds_read_b64_tr_b16 v[104:105], v122 offset:0
    ds_read_b64_tr_b16 v[106:107], v122 offset:160
    ds_read_b64_tr_b16 v[108:109], v122 offset:32
    ds_read_b64_tr_b16 v[110:111], v122 offset:192
    ds_read_b128 v[100:103], v121
    ds_read_b64_tr_b16 v[112:113], v122 offset:1280
    ds_read_b64_tr_b16 v[114:115], v122 offset:1440
    ds_read_b64_tr_b16 v[116:117], v122 offset:1312
    ds_read_b64_tr_b16 v[118:119], v122 offset:1472
    s_waitcnt lgkmcnt(0)
    s_waitcnt vmcnt(6)
    s_barrier
    v_mfma_f32_16x16x32_bf16 v[0:3], v[96:99], v[104:107], v[0:3]
    v_mfma_f32_16x16x32_bf16 v[4:7], v[96:99], v[108:111], v[4:7]
    v_mfma_f32_16x16x32_bf16 v[0:3], v[100:103], v[112:115], v[0:3]
    v_mfma_f32_16x16x32_bf16 v[4:7], v[100:103], v[116:119], v[4:7]
    s_mov_b32 m0, s45
    s_nop 0
    buffer_load_dwordx4 v12, s[24:27], s44 offen lds
    buffer_load_dwordx4 v12, s[24:27], s44 offen offset:1024 lds
    s_mov_b32 exec_hi, 0
    buffer_load_dwordx4 v12, s[24:27], s44 offen offset:2048 lds
    s_mov_b64 exec, -1
    s_add_u32 s44, s44, 2560
    s_add_u32 s45, s45, 2560
    s_cmp_ge_u32 s45, 157696
    s_cselect_b32 s45, 147456, s45
    s_add_u32 s47, s47, 16384
    s_and_b32 s47, s47, 0xffff
    s_add_u32 s48, s48, 2560
    s_cmp_ge_u32 s48, 10240
    s_cselect_b32 s48, 0, s48
    v_add_u32 v120, s47, v13
    v_add_u32 v121, s47, v14
    v_add_u32 v122, s48, v15
    ds_read_b128 v[96:99], v120
    ds_read_b64_tr_b16 v[104:105], v122 offset:0
    ds_read_b64_tr_b16 v[106:107], v122 offset:160
    ds_read_b64_tr_b16 v[108:109], v122 offset:32
    ds_read_b64_tr_b16 v[110:111], v122 offset:192
    ds_read_b128 v[100:103], v121
    ds_read_b64_tr_b16 v[112:113], v122 offset:1280
    ds_read_b64_tr_b16 v[114:115], v122 offset:1440
    ds_read_b64_tr_b16 v[116:117], v122 offset:1312
    ds_read_b64_tr_b16 v[118:119], v122 offset:1472
    s_waitcnt lgkmcnt(0)
    s_waitcnt vmcnt(6)
    s_barrier
    v_mfma_f32_16x16x32_bf16 v[0:3], v[96:99], v[104:107], v[0:3]
    v_mfma_f32_16x16x32_bf16 v[4:7], v[96:99], v[108:111], v[4:7]
    v_mfma_f32_16x16x32_bf16 v[0:3], v[100:103], v[112:115], v[0:3]
    v_mfma_f32_16x16x32_bf16 v[4:7], v[100:103], v[116:119], v[4:7]
    s_mov_b32 m0, s45
    s_nop 0
    buffer_load_dwordx4 v12, s[24:27], s44 offen lds
    buffer_load_dwordx4 v12, s[24:27], s44 offen offset:1024 lds
    s_mov_b32 exec_hi, 0
    buffer_load_dwordx4 v12, s[24:27], s44 offen offset:2048 lds
    s_mov_b64 exec, -1
    s_add_u32 s44, s44, 2560
    s_add_u32 s45, s45, 2560
    s_cmp_ge_u32 s45, 157696
    s_cselect_b32 s45, 147456, s45
    s_add_u32 s47, s47, 16384
    s_and_b32 s47, s47, 0xffff
    s_add_u32 s48, s48, 2560
    s_cmp_ge_u32 s48, 10240
    s_cselect_b32 s48, 0, s48
    v_add_u32 v120, s47, v13
    v_add_u32 v121, s47, v14
    v_add_u32 v122, s48, v15
    ds_read_b128 v[96:99], v120
    ds_read_b64_tr_b16 v[104:105], v122 offset:0
    ds_read_b64_tr_b16 v[106:107], v122 offset:160
    ds_read_b64_tr_b16 v[108:109], v122 offset:32
    ds_read_b64_tr_b16 v[110:111], v122 offset:192
    ds_read_b128 v[100:103], v121
    ds_read_b64_tr_b16 v[112:113], v122 offset:1280
    ds_read_b64_tr_b16 v[114:115], v122 offset:1440
    ds_read_b64_tr_b16 v[116:117], v122 offset:1312
    ds_read_b64_tr_b16 v[118:119], v122 offset:1472
    s_waitcnt lgkmcnt(0)
    s_waitcnt vmcnt(6)
    s_barrier
    v_mfma_f32_16x16x32_bf16 v[0:3], v[96:99], v[104:107], v[0:3]
    v_mfma_f32_16x16x32_bf16 v[4:7], v[96:99], v[108:111], v[4:7]
    v_mfma_f32_16x16x32_bf16 v[0:3], v[100:103], v[112:115], v[0:3]
    v_mfma_f32_16x16x32_bf16 v[4:7], v[100:103], v[116:119], v[4:7]
    s_mov_b32 m0, s45
    s_nop 0
    buffer_load_dwordx4 v12, s[24:27], s44 offen lds
    buffer_load_dwordx4 v12, s[24:27], s44 offen offset:1024 lds
    s_mov_b32 exec_hi, 0
    buffer_load_dwordx4 v12, s[24:27], s44 offen offset:2048 lds
    s_mov_b64 exec, -1
    s_add_u32 s44, s44, 2560
    s_add_u32 s45, s45, 2560
    s_cmp_ge_u32 s45, 157696
    s_cselect_b32 s45, 147456, s45
    s_add_u32 s47, s47, 16384
    s_and_b32 s47, s47, 0xffff
    s_add_u32 s48, s48, 2560
    s_cmp_ge_u32 s48, 10240
    s_cselect_b32 s48, 0, s48
    v_add_u32 v120, s47, v13
    v_add_u32 v121, s47, v14
    v_add_u32 v122, s48, v15
    ds_read_b128 v[96:99], v120
    ds_read_b64_tr_b16 v[104:105], v122 offset:0
    ds_read_b64_tr_b16 v[106:107], v122 offset:160
    ds_read_b64_tr_b16 v[108:109], v122 offset:32
    ds_read_b64_tr_b16 v[110:111], v122 offset:192
    ds_read_b128 v[100:103], v121
    ds_read_b64_tr_b16 v[112:113], v122 offset:1280
    ds_read_b64_tr_b16 v[114:115], v122 offset:1440
    ds_read_b64_tr_b16 v[116:117], v122 offset:1312
    ds_read_b64_tr_b16 v[118:119], v122 offset:1472
    s_waitcnt lgkmcnt(0)
    s_waitcnt vmcnt(6)
    s_barrier
    v_mfma_f32_16x16x32_bf16 v[0:3], v[96:99], v[104:107], v[0:3]
    v_mfma_f32_16x16x32_bf16 v[4:7], v[96:99], v[108:111], v[4:7]
    v_mfma_f32_16x16x32_bf16 v[0:3], v[100:103], v[112:115], v[0:3]
    v_mfma_f32_16x16x32_bf16 v[4:7], v[100:103], v[116:119], v[4:7]
    s_mov_b32 m0, s45
    s_nop 0
    buffer_load_dwordx4 v12, s[24:27], s44 offen lds
    buffer_load_dwordx4 v12, s[24:27], s44 offen offset:1024 lds
    s_mov_b32 exec_hi, 0
    buffer_load_dwordx4 v12, s[24:27], s44 offen offset:2048 lds
    s_mov_b64 exec, -1
    s_add_u32 s44, s44, 2560
    s_add_u32 s45, s45, 2560
    s_cmp_ge_u32 s45, 157696
    s_cselect_b32 s45, 147456, s45
    s_add_u32 s47, s47, 16384
    s_and_b32 s47, s47, 0xffff
    s_add_u32 s48, s48, 2560
    s_cmp_ge_u32 s48, 10240
    s_cselect_b32 s48, 0, s48
    v_add_u32 v120, s47, v13
    v_add_u32 v121, s47, v14
    v_add_u32 v122, s48, v15
    ds_read_b128 v[96:99], v120
    ds_read_b64_tr_b16 v[104:105], v122 offset:0
    ds_read_b64_tr_b16 v[106:107], v122 offset:160
    ds_read_b64_tr_b16 v[108:109], v122 offset:32
    ds_read_b64_tr_b16 v[110:111], v122 offset:192
    ds_read_b128 v[100:103], v121
    ds_read_b64_tr_b16 v[112:113], v122 offset:1280
    ds_read_b64_tr_b16 v[114:115], v122 offset:1440
    ds_read_b64_tr_b16 v[116:117], v122 offset:1312
    ds_read_b64_tr_b16 v[118:119], v122 offset:1472
    s_waitcnt lgkmcnt(0)
    s_waitcnt vmcnt(6)
    s_barrier
    v_mfma_f32_16x16x32_bf16 v[0:3], v[96:99], v[104:107], v[0:3]
    v_mfma_f32_16x16x32_bf16 v[4:7], v[96:99], v[108:111], v[4:7]
    v_mfma_f32_16x16x32_bf16 v[0:3], v[100:103], v[112:115], v[0:3]
    v_mfma_f32_16x16x32_bf16 v[4:7], v[100:103], v[116:119], v[4:7]
    s_mov_b32 m0, s45
    s_nop 0
    buffer_load_dwordx4 v12, s[24:27], s44 offen lds
    buffer_load_dwordx4 v12, s[24:27], s44 offen offset:1024 lds
    s_mov_b32 exec_hi, 0
    buffer_load_dwordx4 v12, s[24:27], s44 offen offset:2048 lds
    s_mov_b64 exec, -1
    s_add_u32 s44, s44, 2560
    s_add_u32 s45, s45, 2560
    s_cmp_ge_u32 s45, 157696
    s_cselect_b32 s45, 147456, s45
    s_add_u32 s47, s47, 16384
    s_and_b32 s47, s47, 0xffff
    s_add_u32 s48, s48, 2560
    s_cmp_ge_u32 s48, 10240
    s_cselect_b32 s48, 0, s48
    v_add_u32 v120, s47, v13
    v_add_u32 v121, s47, v14
    v_add_u32 v122, s48, v15
    ds_read_b128 v[96:99], v120
    ds_read_b64_tr_b16 v[104:105], v122 offset:0
    ds_read_b64_tr_b16 v[106:107], v122 offset:160
    ds_read_b64_tr_b16 v[108:109], v122 offset:32
    ds_read_b64_tr_b16 v[110:111], v122 offset:192
    ds_read_b128 v[100:103], v121
    ds_read_b64_tr_b16 v[112:113], v122 offset:1280
    ds_read_b64_tr_b16 v[114:115], v122 offset:1440
    ds_read_b64_tr_b16 v[116:117], v122 offset:1312
    ds_read_b64_tr_b16 v[118:119], v122 offset:1472
    s_waitcnt lgkmcnt(0)
    s_waitcnt vmcnt(6)
    s_barrier
    v_mfma_f32_16x16x32_bf16 v[0:3], v[96:99], v[104:107], v[0:3]
    v_mfma_f32_16x16x32_bf16 v[4:7], v[96:99], v[108:111], v[4:7]
    v_mfma_f32_16x16x32_bf16 v[0:3], v[100:103], v[112:115], v[0:3]
    v_mfma_f32_16x16x32_bf16 v[4:7], v[100:103], v[116:119], v[4:7]
    s_add_u32 s47, s47, 16384
    s_and_b32 s47, s47, 0xffff
    s_add_u32 s48, s48, 2560
    s_cmp_ge_u32 s48, 10240
    s_cselect_b32 s48, 0, s48
    v_add_u32 v120, s47, v13
    v_add_u32 v121, s47, v14
    v_add_u32 v122, s48, v15
    ds_read_b128 v[96:99], v120
    ds_read_b64_tr_b16 v[104:105], v122 offset:0
    ds_read_b64_tr_b16 v[106:107], v122 offset:160
    ds_read_b64_tr_b16 v[108:109], v122 offset:32
    ds_read_b64_tr_b16 v[110:111], v122 offset:192
    ds_read_b128 v[100:103], v121
    ds_read_b64_tr_b16 v[112:113], v122 offset:1280
    ds_read_b64_tr_b16 v[114:115], v122 offset:1440
    ds_read_b64_tr_b16 v[116:117], v122 offset:1312
    ds_read_b64_tr_b16 v[118:119], v122 offset:1472
    s_waitcnt lgkmcnt(0)
    s_waitcnt vmcnt(3)
    s_barrier
    v_mfma_f32_16x16x32_bf16 v[0:3], v[96:99], v[104:107], v[0:3]
    v_mfma_f32_16x16x32_bf16 v[4:7], v[96:99], v[108:111], v[4:7]
    v_mfma_f32_16x16x32_bf16 v[0:3], v[100:103], v[112:115], v[0:3]
    v_mfma_f32_16x16x32_bf16 v[4:7], v[100:103], v[116:119], v[4:7]
    s_add_u32 s47, s47, 16384
    s_and_b32 s47, s47, 0xffff
    s_add_u32 s48, s48, 2560
    s_cmp_ge_u32 s48, 10240
    s_cselect_b32 s48, 0, s48
    v_add_u32 v120, s47, v13
    v_add_u32 v121, s47, v14
    v_add_u32 v122, s48, v15
    ds_read_b128 v[96:99], v120
    ds_read_b64_tr_b16 v[104:105], v122 offset:0
    ds_read_b64_tr_b16 v[106:107], v122 offset:160
    ds_read_b64_tr_b16 v[108:109], v122 offset:32
    ds_read_b64_tr_b16 v[110:111], v122 offset:192
    ds_read_b128 v[100:103], v121
    ds_read_b64_tr_b16 v[112:113], v122 offset:1280
    ds_read_b64_tr_b16 v[114:115], v122 offset:1440
    ds_read_b64_tr_b16 v[116:117], v122 offset:1312
    ds_read_b64_tr_b16 v[118:119], v122 offset:1472
    s_waitcnt lgkmcnt(0)
    s_waitcnt vmcnt(0)
    s_barrier
    v_mfma_f32_16x16x32_bf16 v[0:3], v[96:99], v[104:107], v[0:3]
    v_mfma_f32_16x16x32_bf16 v[4:7], v[96:99], v[108:111], v[4:7]
    v_mfma_f32_16x16x32_bf16 v[0:3], v[100:103], v[112:115], v[0:3]
    v_mfma_f32_16x16x32_bf16 v[4:7], v[100:103], v[116:119], v[4:7]
    s_add_u32 s47, s47, 16384
    s_and_b32 s47, s47, 0xffff
    s_add_u32 s48, s48, 2560
    s_cmp_ge_u32 s48, 10240
    s_cselect_b32 s48, 0, s48
    v_add_u32 v120, s47, v13
    v_add_u32 v121, s47, v14
    v_add_u32 v122, s48, v15
    ds_read_b128 v[96:99], v120
    ds_read_b64_tr_b16 v[104:105], v122 offset:0
    ds_read_b64_tr_b16 v[106:107], v122 offset:160
    ds_read_b64_tr_b16 v[108:109], v122 offset:32
    ds_read_b64_tr_b16 v[110:111], v122 offset:192
    ds_read_b128 v[100:103], v121
    ds_read_b64_tr_b16 v[112:113], v122 offset:1280
    ds_read_b64_tr_b16 v[114:115], v122 offset:1440
    ds_read_b64_tr_b16 v[116:117], v122 offset:1312
    ds_read_b64_tr_b16 v[118:119], v122 offset:1472
    s_waitcnt lgkmcnt(0)
    s_waitcnt vmcnt(0)
    s_barrier
    v_mfma_f32_16x16x32_bf16 v[0:3], v[96:99], v[104:107], v[0:3]
    v_mfma_f32_16x16x32_bf16 v[4:7], v[96:99], v[108:111], v[4:7]
    v_mfma_f32_16x16x32_bf16 v[0:3], v[100:103], v[112:115], v[0:3]
    v_mfma_f32_16x16x32_bf16 v[4:7], v[100:103], v[116:119], v[4:7]
    s_add_u32 s47, s47, 16384
    s_and_b32 s47, s47, 0xffff
    s_add_u32 s48, s48, 2560
    s_cmp_ge_u32 s48, 10240
    s_cselect_b32 s48, 0, s48
    s_lshl_b32 s39, s37, 1
    s_lshr_b32 s40, s38, 3
    s_add_u32 s39, s39, s40
    s_mul_i32 s52, s39, 5120
    s_add_u32 s52, s52, 5242880
    s_bfe_u32 s56, s38, 0x10002
    s_bfe_u32 s40, s38, 0x10001
    v_and_b32 v124, 15, v123
    v_lshrrev_b32 v125, 4, v123
    v_cvt_pk_bf16_f32 v0, v0, v1
    v_cvt_pk_bf16_f32 v1, v2, v3
    v_cvt_pk_bf16_f32 v4, v4, v5
    v_cvt_pk_bf16_f32 v5, v6, v7
    s_mul_i32 s40, s40, 640
    s_add_u32 s52, s52, s40
    s_mul_i32 s39, s56, 1280
    s_add_u32 s52, s52, s39
    v_and_b32 v126, 1, v125
    v_mul_u32_u24 v126, 320, v126
    v_lshl_add_u32 v126, v124, 4, v126
    v_lshrrev_b32 v127, 1, v125
    v_lshl_add_u32 v126, v127, 3, v126
    buffer_store_dwordx2 v[0:1], v126, s[28:31], s52 offen offset:2560
    v_cmp_gt_u32 vcc, 4, v124
    s_and_b64 exec, exec, vcc
    buffer_store_dwordx2 v[4:5], v126, s[28:31], s52 offen offset:2816
L_proj_done:
    s_endpgm
.globl attn_kernel
.p2align 8
.type attn_kernel,@function
attn_kernel:
    s_cmp_ge_u32 s2, 256
    s_cbranch_scc1 L_attn_done
    s_load_dwordx2 s[4:5], s[0:1], 88
    s_load_dwordx2 s[6:7], s[0:1], 72
    v_lshrrev_b32 v110, 6, v0
    v_and_b32 v111, 63, v0
    v_readfirstlane_b32 s24, v110
    s_nop 3
    s_sub_u32 s27, s24, 1
    s_cmp_eq_u32 s24, 0
    s_cselect_b32 s24, 8, s27
    s_and_b32 s27, s2, 7
    s_lshr_b32 s25, s2, 5
    s_lshl_b32 s25, s25, 3
    s_add_u32 s25, s25, s27
    s_lshr_b32 s26, s2, 3
    s_and_b32 s26, s26, 3
    s_lshl_b32 s26, s26, 3
    s_add_u32 s26, s26, s24
    s_lshl_b32 s26, s26, 1
    s_mov_b32 s20, -1
    s_mov_b32 s21, 0
    s_mov_b32 s22, 0x000fffff
    s_mov_b32 s23, 0x000fffff
    s_mov_b32 s32, 0
    v_lshlrev_b32 v108, 4, v111
    v_and_b32 v112, 31, v111
    v_lshlrev_b32 v113, 4, v112
    s_lshl_b32 s27, s25, 6
    s_add_u32 s27, s27, s26
    s_mul_i32 s27, s27, 1280
    s_add_u32 s27, s27, 6291456
    s_min_u32 s33, s25, 32
    s_mul_i32 s29, s33, 163840
    s_lshl_b32 s33, s24, 10
    s_add_u32 s29, s29, s33
    s_mov_b32 m0, s33
    s_mov_b32 s10, 22020096
    s_mov_b32 s11, 0x00020000
    s_waitcnt lgkmcnt(0)
    s_mov_b32 s8, s4
    s_and_b32 s9, s5, 0xffff
    s_cmp_eq_u32 s24, 8
    s_cbranch_scc0 L_attn_main
    s_mov_b32 m0, 0
    s_sub_u32 s29, s29, s33
    s_mov_b32 s28, 0
L_attn_ld2423:
    buffer_load_dwordx4 v108, s[8:11], s29 offen offset:0 lds
    buffer_load_dwordx4 v108, s[8:11], s29 offen offset:1024 lds
    buffer_load_dwordx4 v108, s[8:11], s29 offen offset:2048 lds
    buffer_load_dwordx4 v108, s[8:11], s29 offen offset:3072 lds
    s_add_u32 s29, s29, 4096
    s_add_u32 m0, m0, 4096
    s_add_u32 s28, s28, 1
    s_cmp_lt_u32 s28, 4
    s_cbranch_scc1 L_attn_ld2423
    s_waitcnt vmcnt(0)
    s_barrier
    s_mov_b32 s28, 0
L_attn_ld2436:
    buffer_load_dwordx4 v108, s[8:11], s29 offen offset:0 lds
    buffer_load_dwordx4 v108, s[8:11], s29 offen offset:1024 lds
    buffer_load_dwordx4 v108, s[8:11], s29 offen offset:2048 lds
    buffer_load_dwordx4 v108, s[8:11], s29 offen offset:3072 lds
    s_add_u32 s29, s29, 4096
    s_add_u32 m0, m0, 4096
    s_add_u32 s28, s28, 1
    s_cmp_lt_u32 s28, 16
    s_cbranch_scc1 L_attn_ld2436
    s_waitcnt vmcnt(32)
    s_barrier
    s_mov_b32 s28, 0
L_attn_ld2449:
    buffer_load_dwordx4 v108, s[8:11], s29 offen offset:0 lds
    buffer_load_dwordx4 v108, s[8:11], s29 offen offset:1024 lds
    buffer_load_dwordx4 v108, s[8:11], s29 offen offset:2048 lds
    buffer_load_dwordx4 v108, s[8:11], s29 offen offset:3072 lds
    s_add_u32 s29, s29, 4096
    s_add_u32 m0, m0, 4096
    s_add_u32 s28, s28, 1
    s_cmp_lt_u32 s28, 20
    s_cbranch_scc1 L_attn_ld2449
    s_waitcnt vmcnt(0)
    s_barrier
    s_lshr_b32 s27, s2, 3
    s_mul_i32 s27, s27, 51200
    s_add_u32 s27, s27, 19922944
    v_lshlrev_b32 v110, 7, v111
    buffer_load_dword v0, v110, s[8:11], s27 offen
    s_add_u32 s27, s27, 8192
    buffer_load_dword v1, v110, s[8:11], s27 offen
    s_add_u32 s27, s27, 8192
    buffer_load_dword v2, v110, s[8:11], s27 offen
    s_add_u32 s27, s27, 8192
    buffer_load_dword v3, v110, s[8:11], s27 offen
    s_add_u32 s27, s27, 8192
    buffer_load_dword v4, v110, s[8:11], s27 offen
    s_add_u32 s27, s27, 8192
    buffer_load_dword v5, v110, s[8:11], s27 offen
    s_add_u32 s27, s27, 8192
    s_mov_b32 exec_lo, 0xffff
    s_mov_b32 exec_hi, 0
    buffer_load_dword v6, v110, s[8:11], s27 offen
    s_add_u32 s27, s27, 8192
    s_mov_b64 exec, -1
    s_lshr_b32 s27, s25, 3
    s_mul_i32 s29, s27, 5120
    s_add_u32 s29, s29, 19922944
    s_barrier
    s_mov_b32 s33, 0
    s_mov_b32 s28, 0
L_attn_wa:
    s_add_u32 s27, s29, 0
    s_mov_b32 m0, s33
    s_add_u32 s33, s33, 4096
    buffer_load_dwordx4 v108, s[8:11], s27 offen offset:0 lds
    buffer_load_dwordx4 v108, s[8:11], s27 offen offset:1024 lds
    buffer_load_dwordx4 v108, s[8:11], s27 offen offset:2048 lds
    buffer_load_dwordx4 v108, s[8:11], s27 offen offset:3072 lds
    s_mov_b32 m0, s33
    s_add_u32 s27, s27, 4096
    buffer_load_dwordx4 v108, s[8:11], s27 offen lds
    s_add_u32 s33, s33, 1024
    s_add_u32 s27, s29, 819200
    s_mov_b32 m0, s33
    s_add_u32 s33, s33, 4096
    buffer_load_dwordx4 v108, s[8:11], s27 offen offset:0 lds
    buffer_load_dwordx4 v108, s[8:11], s27 offen offset:1024 lds
    buffer_load_dwordx4 v108, s[8:11], s27 offen offset:2048 lds
    buffer_load_dwordx4 v108, s[8:11], s27 offen offset:3072 lds
    s_mov_b32 m0, s33
    s_add_u32 s27, s27, 4096
    buffer_load_dwordx4 v108, s[8:11], s27 offen lds
    s_add_u32 s33, s33, 1024
    s_add_u32 s29, s29, 40960
    s_add_u32 s28, s28, 1
    s_cmp_lt_u32 s28, 14
    s_cbranch_scc1 L_attn_wa
    s_barrier
    s_mov_b32 s33, 143360
    s_mov_b32 s28, 0
L_attn_wb:
    s_add_u32 s27, s29, 0
    s_mov_b32 m0, s33
    s_add_u32 s33, s33, 4096
    buffer_load_dwordx4 v108, s[8:11], s27 offen offset:0 lds
    buffer_load_dwordx4 v108, s[8:11], s27 offen offset:1024 lds
    buffer_load_dwordx4 v108, s[8:11], s27 offen offset:2048 lds
    buffer_load_dwordx4 v108, s[8:11], s27 offen offset:3072 lds
    s_mov_b32 m0, s33
    s_add_u32 s27, s27, 4096
    buffer_load_dwordx4 v108, s[8:11], s27 offen lds
    s_add_u32 s33, s33, 1024
    s_add_u32 s27, s29, 819200
    s_mov_b32 m0, s33
    s_add_u32 s33, s33, 4096
    buffer_load_dwordx4 v108, s[8:11], s27 offen offset:0 lds
    buffer_load_dwordx4 v108, s[8:11], s27 offen offset:1024 lds
    buffer_load_dwordx4 v108, s[8:11], s27 offen offset:2048 lds
    buffer_load_dwordx4 v108, s[8:11], s27 offen offset:3072 lds
    s_mov_b32 m0, s33
    s_add_u32 s27, s27, 4096
    buffer_load_dwordx4 v108, s[8:11], s27 offen lds
    s_add_u32 s33, s33, 1024
    s_add_u32 s29, s29, 40960
    s_add_u32 s28, s28, 1
    s_cmp_lt_u32 s28, 2
    s_cbranch_scc1 L_attn_wb
    s_waitcnt vmcnt(0)
    s_barrier
    s_endpgm
L_attn_main:
    buffer_load_dwordx4 v[64:67], v108, s[8:11], s27 offen offset:0
    buffer_load_dwordx4 v[68:71], v108, s[8:11], s27 offen offset:1024
    buffer_load_dwordx4 v[72:75], v113, s[8:11], s27 offen offset:2048
    s_lshl_b32 s27, s26, 7
    s_add_u32 s27, s27, 18874368
    v_lshlrev_b32 v113, 2, v112
    buffer_load_dword v114, v113, s[8:11], s27 offen offset:0
    buffer_load_dword v115, v113, s[8:11], s27 offen offset:128
    v_lshrrev_b32 v110, 5, v111
    v_mul_u32_u24 v109, 320, v110
    v_lshl_add_u32 v109, v112, 4, v109
    v_lshrrev_b32 v117, 4, v112
    v_mul_u32_u24 v117, 1024, v117
    v_and_b32 v116, 15, v112
    v_lshl_add_u32 v117, v116, 4, v117
    v_lshl_add_u32 v116, v110, 8, v117
    s_mul_i32 s36, s26, 2048
    s_lshr_b32 s27, s25, 4
    s_mul_i32 s27, s27, 1310720
    s_add_u32 s36, s36, s27
    s_add_u32 s36, s36, 12582912
    s_bfe_u32 s27, s25, 0x10003
    s_mul_i32 s27, s27, 131072
    s_add_u32 s37, s36, s27
    s_bfe_u32 s27, s25, 0x20001
    s_lshl_b32 s27, s27, 8
    s_add_u32 s37, s37, s27
    s_and_b32 s27, s25, 1
    s_lshl_b32 s27, s27, 3
    s_add_u32 s37, s37, s27
    s_add_u32 s37, s37, 1048576
    s_bfe_u32 s27, s25, 0x30001
    s_mul_i32 s27, s27, 131072
    s_add_u32 s36, s36, s27
    s_and_b32 s27, s25, 1
    s_lshl_b32 s27, s27, 9
    s_add_u32 s36, s36, s27
    v_mov_b32 v84, 0x3f803f80
    v_mov_b32 v85, 0x00003f80
    v_mov_b32 v86, 0x3f803f80
    v_mov_b32 v87, 0x00003f80
    v_mov_b32 v88, 0x3f803f80
    v_mov_b32 v89, 0x00003f80
    v_mov_b32 v90, 0x3f803f80
    v_mov_b32 v91, 0x00003f80
    v_mov_b32 v92, 0
    v_mov_b32 v93, 0
    v_mov_b32 v94, 0
    v_mov_b32 v95, 0
    v_mov_b32 v96, 0
    v_mov_b32 v97, 0
    v_mov_b32 v98, 0
    v_mov_b32 v99, 0
    v_mov_b32 v100, 0
    v_mov_b32 v101, 0
    v_mov_b32 v102, 0
    v_mov_b32 v103, 0
    v_mov_b32 v104, 0
    v_mov_b32 v105, 0
    v_mov_b32 v106, 0
    v_mov_b32 v107, 0
    s_mov_b32 exec_lo, 0x01100000
    s_mov_b32 exec_hi, 0x01100000
    v_mov_b32 v92, 0x3f803f80
    v_mov_b32 v93, 0x3f803f80
    v_mov_b32 v94, 0x3f803f80
    v_mov_b32 v95, 0x3f803f80
    v_mov_b32 v96, 0x3f803f80
    v_mov_b32 v97, 0x3f803f80
    v_mov_b32 v98, 0x3f803f80
    v_mov_b32 v99, 0x3f803f80
    v_mov_b32 v100, 0x3f803f80
    v_mov_b32 v101, 0x3f803f80
    v_mov_b32 v102, 0x3f803f80
    v_mov_b32 v103, 0x3f803f80
    v_mov_b32 v104, 0x3f803f80
    v_mov_b32 v105, 0x3f803f80
    v_mov_b32 v106, 0x3f803f80
    v_mov_b32 v107, 0x3f803f80
    s_mov_b64 exec, -1
    v_mov_b32 v32, 0
    v_mov_b32 v33, 0
    v_mov_b32 v34, 0
    v_mov_b32 v35, 0
    v_mov_b32 v36, 0
    v_mov_b32 v37, 0
    v_mov_b32 v38, 0
    v_mov_b32 v39, 0
    v_mov_b32 v40, 0
    v_mov_b32 v41, 0
    v_mov_b32 v42, 0
    v_mov_b32 v43, 0
    v_mov_b32 v44, 0
    v_mov_b32 v45, 0
    v_mov_b32 v46, 0
    v_mov_b32 v47, 0
    v_mov_b32 v48, 0
    v_mov_b32 v49, 0
    v_mov_b32 v50, 0
    v_mov_b32 v51, 0
    v_mov_b32 v52, 0
    v_mov_b32 v53, 0
    v_mov_b32 v54, 0
    v_mov_b32 v55, 0
    v_mov_b32 v56, 0
    v_mov_b32 v57, 0
    v_mov_b32 v58, 0
    v_mov_b32 v59, 0
    v_mov_b32 v60, 0
    v_mov_b32 v61, 0
    v_mov_b32 v62, 0
    v_mov_b32 v63, 0
    s_cmp_lt_u32 s25, 32
    s_cselect_b32 s30, 0, 1.0
    s_cselect_b32 s31, 1.0, -1.0
    s_waitcnt vmcnt(0)
    s_barrier
    s_not_b64 exec, s[20:21]
    v_mov_b32 v72, 0
    v_mov_b32 v73, 0
    v_mov_b32 v74, 0
    v_mov_b32 v75, 0
    s_mov_b64 exec, -1
    ds_read_b128 v[76:79], v108 offset:0
    s_mov_b64 exec, s[20:21]
    ds_read_b128 v[84:87], v108 offset:2048
    s_mov_b64 exec, -1
    ds_read_b128 v[80:83], v108 offset:1024
    s_mov_b64 exec, s[20:21]
    ds_read_b128 v[88:91], v108 offset:7168
    s_mov_b64 exec, s[22:23]
    ds_read_b128 v[92:95], v109 offset:2560
    ds_read_b128 v[96:99], v109 offset:3200
    s_mov_b64 exec, -1
    s_waitcnt lgkmcnt(4)
    v_mfma_f32_32x32x16_bf16 v[0:15], v[76:79], v[64:67], 0
    v_mfma_f32_32x32x8_bf16 v[0:15], v[84:85], v[72:73], v[0:15]
    v_mfma_f32_32x32x16_bf16 v[16:31], v[76:79], v[68:71], 0
    v_mfma_f32_32x32x8_bf16 v[16:31], v[84:85], v[74:75], v[16:31]
    s_nop 7
    s_nop 3
    v_max3_f32 v110, v0, v1, v2
    v_max3_f32 v110, v110, v3, v4
    v_max3_f32 v110, v110, v5, v6
    v_max3_f32 v110, v110, v7, v8
    v_max3_f32 v110, v110, v9, v10
    v_max3_f32 v110, v110, v11, v12
    v_max3_f32 v110, v110, v13, v14
    v_max_f32 v110, v110, v15
    v_mov_b32 v111, v110
    s_nop 1
    v_permlane32_swap_b32 v110, v111
    s_nop 1
    v_max_f32 v110, v110, v111
    v_sub_f32 v110, 0, v110
    v_and_b32 v111, 0xffff0000, v110
    v_sub_f32 v110, v110, v111
    v_and_b32 v112, 0xffff0000, v110
    v_sub_f32 v110, v110, v112
    v_lshrrev_b32 v111, 16, v111
    s_not_b64 exec, s[20:21]
    v_or_b32 v72, v111, v112
    v_lshrrev_b32 v73, 16, v110
    s_mov_b64 exec, -1
    s_nop 1
    v_mfma_f32_32x32x16_bf16 v[0:15], v[76:79], v[64:67], 0
    v_mfma_f32_32x32x8_bf16 v[0:15], v[84:85], v[72:73], v[0:15]
    s_nop 7
    v_max3_f32 v110, v16, v17, v18
    v_max3_f32 v110, v110, v19, v20
    v_max3_f32 v110, v110, v21, v22
    v_max3_f32 v110, v110, v23, v24
    v_max3_f32 v110, v110, v25, v26
    v_max3_f32 v110, v110, v27, v28
    v_max3_f32 v110, v110, v29, v30
    v_max_f32 v110, v110, v31
    v_mov_b32 v111, v110
    s_nop 1
    v_permlane32_swap_b32 v110, v111
    s_nop 1
    v_max_f32 v110, v110, v111
    v_sub_f32 v110, 0, v110
    v_and_b32 v111, 0xffff0000, v110
    v_sub_f32 v110, v110, v111
    v_and_b32 v112, 0xffff0000, v110
    v_sub_f32 v110, v110, v112
    v_lshrrev_b32 v111, 16, v111
    s_not_b64 exec, s[20:21]
    v_or_b32 v74, v111, v112
    v_lshrrev_b32 v75, 16, v110
    s_mov_b64 exec, -1
    v_mov_b32 v24, 0
    v_mov_b32 v25, 0
    v_mov_b32 v26, 0
    v_mov_b32 v27, 0
    s_waitcnt lgkmcnt(0)
    s_mov_b32 s28, 0
    s_cmp_lt_u32 s24, 4
    s_cbranch_scc1 L_attn_lo
    s_setprio 1
L_attn_lo:
L_attn_loop:
    s_waitcnt lgkmcnt(0)
    v_mfma_f32_32x32x16_bf16 v[48:63], v[104:107], v[24:27], v[48:63]
    s_mov_b64 exec, s[22:23]
    ds_read_b128 v[100:103], v109 offset:3840
    ds_read_b128 v[104:107], v109 offset:4480
    s_mov_b64 exec, -1
    v_exp_f32 v0, v0
    v_exp_f32 v1, v1
    v_exp_f32 v2, v2
    v_exp_f32 v3, v3
    v_mfma_f32_32x32x16_bf16 v[16:31], v[76:79], v[68:71], 0
    v_exp_f32 v4, v4
    v_exp_f32 v5, v5
    v_exp_f32 v6, v6
    v_exp_f32 v7, v7
    v_cvt_pk_bf16_f32 v0, v0, v1
    v_cvt_pk_bf16_f32 v1, v2, v3
    v_cvt_pk_bf16_f32 v2, v4, v5
    v_cvt_pk_bf16_f32 v3, v6, v7
    v_mfma_f32_32x32x8_bf16 v[16:31], v[84:85], v[74:75], v[16:31]
    ds_read_b128 v[76:79], v108 offset:5120
    v_exp_f32 v8, v8
    v_exp_f32 v9, v9
    v_exp_f32 v10, v10
    v_exp_f32 v11, v11
    v_mfma_f32_32x32x16_bf16 v[32:47], v[92:95], v[0:3], v[32:47]
    v_exp_f32 v12, v12
    v_exp_f32 v13, v13
    v_exp_f32 v14, v14
    v_exp_f32 v15, v15
    v_cvt_pk_bf16_f32 v8, v8, v9
    v_cvt_pk_bf16_f32 v9, v10, v11
    v_cvt_pk_bf16_f32 v10, v12, v13
    v_cvt_pk_bf16_f32 v11, v14, v15
    s_nop 1
    v_mfma_f32_32x32x16_bf16 v[32:47], v[96:99], v[8:11], v[32:47]
    v_exp_f32 v16, v16
    v_exp_f32 v17, v17
    v_exp_f32 v18, v18
    v_exp_f32 v19, v19
    v_mfma_f32_32x32x16_bf16 v[0:15], v[80:83], v[64:67], 0
    v_exp_f32 v20, v20
    v_exp_f32 v21, v21
    v_exp_f32 v22, v22
    v_exp_f32 v23, v23
    v_cvt_pk_bf16_f32 v16, v16, v17
    v_cvt_pk_bf16_f32 v17, v18, v19
    v_cvt_pk_bf16_f32 v18, v20, v21
    v_cvt_pk_bf16_f32 v19, v22, v23
    v_mfma_f32_32x32x8_bf16 v[0:15], v[86:87], v[72:73], v[0:15]
    v_exp_f32 v24, v24
    v_exp_f32 v25, v25
    v_exp_f32 v26, v26
    v_exp_f32 v27, v27
    v_mfma_f32_32x32x16_bf16 v[48:63], v[92:95], v[16:19], v[48:63]
    v_exp_f32 v28, v28
    v_exp_f32 v29, v29
    v_exp_f32 v30, v30
    v_exp_f32 v31, v31
    v_cvt_pk_bf16_f32 v24, v24, v25
    v_cvt_pk_bf16_f32 v25, v26, v27
    v_cvt_pk_bf16_f32 v26, v28, v29
    v_cvt_pk_bf16_f32 v27, v30, v31
    s_nop 0
    s_waitcnt lgkmcnt(0)
    v_mfma_f32_32x32x16_bf16 v[48:63], v[96:99], v[24:27], v[48:63]
    s_mov_b64 exec, s[22:23]
    ds_read_b128 v[92:95], v109 offset:7680
    ds_read_b128 v[96:99], v109 offset:8320
    s_mov_b64 exec, -1
    v_exp_f32 v0, v0
    v_exp_f32 v1, v1
    v_exp_f32 v2, v2
    v_exp_f32 v3, v3
    v_mfma_f32_32x32x16_bf16 v[16:31], v[80:83], v[68:71], 0
    v_exp_f32 v4, v4
    v_exp_f32 v5, v5
    v_exp_f32 v6, v6
    v_exp_f32 v7, v7
    v_cvt_pk_bf16_f32 v0, v0, v1
    v_cvt_pk_bf16_f32 v1, v2, v3
    v_cvt_pk_bf16_f32 v2, v4, v5
    v_cvt_pk_bf16_f32 v3, v6, v7
    v_mfma_f32_32x32x8_bf16 v[16:31], v[86:87], v[74:75], v[16:31]
    ds_read_b128 v[80:83], v108 offset:6144
    s_mov_b64 exec, s[20:21]
    ds_read_b128 v[84:87], v108 offset:12288
    s_mov_b64 exec, -1
    v_exp_f32 v8, v8
    v_exp_f32 v9, v9
    v_exp_f32 v10, v10
    v_exp_f32 v11, v11
    v_mfma_f32_32x32x16_bf16 v[32:47], v[100:103], v[0:3], v[32:47]
    v_exp_f32 v12, v12
    v_exp_f32 v13, v13
    v_exp_f32 v14, v14
    v_exp_f32 v15, v15
    v_cvt_pk_bf16_f32 v8, v8, v9
    v_cvt_pk_bf16_f32 v9, v10, v11
    v_cvt_pk_bf16_f32 v10, v12, v13
    v_cvt_pk_bf16_f32 v11, v14, v15
    s_nop 1
    v_mfma_f32_32x32x16_bf16 v[32:47], v[104:107], v[8:11], v[32:47]
    v_exp_f32 v16, v16
    v_exp_f32 v17, v17
    v_exp_f32 v18, v18
    v_exp_f32 v19, v19
    v_mfma_f32_32x32x16_bf16 v[0:15], v[76:79], v[64:67], 0
    v_exp_f32 v20, v20
    v_exp_f32 v21, v21
    v_exp_f32 v22, v22
    v_exp_f32 v23, v23
    v_cvt_pk_bf16_f32 v16, v16, v17
    v_cvt_pk_bf16_f32 v17, v18, v19
    v_cvt_pk_bf16_f32 v18, v20, v21
    v_cvt_pk_bf16_f32 v19, v22, v23
    v_mfma_f32_32x32x8_bf16 v[0:15], v[88:89], v[72:73], v[0:15]
    v_exp_f32 v24, v24
    v_exp_f32 v25, v25
    v_exp_f32 v26, v26
    v_exp_f32 v27, v27
    v_mfma_f32_32x32x16_bf16 v[48:63], v[100:103], v[16:19], v[48:63]
    v_exp_f32 v28, v28
    v_exp_f32 v29, v29
    v_exp_f32 v30, v30
    v_exp_f32 v31, v31
    v_cvt_pk_bf16_f32 v24, v24, v25
    v_cvt_pk_bf16_f32 v25, v26, v27
    v_cvt_pk_bf16_f32 v26, v28, v29
    v_cvt_pk_bf16_f32 v27, v30, v31
    s_nop 0
    s_cmp_gt_u32 s28, 1
    s_cbranch_scc1 L_attn_nobar
    s_barrier
L_attn_nobar:
    s_waitcnt lgkmcnt(0)
    v_mfma_f32_32x32x16_bf16 v[48:63], v[104:107], v[24:27], v[48:63]
    s_mov_b64 exec, s[22:23]
    ds_read_b128 v[100:103], v109 offset:8960
    ds_read_b128 v[104:107], v109 offset:9600
    s_mov_b64 exec, -1
    v_exp_f32 v0, v0
    v_exp_f32 v1, v1
    v_exp_f32 v2, v2
    v_exp_f32 v3, v3
    v_mfma_f32_32x32x16_bf16 v[16:31], v[76:79], v[68:71], 0
    v_exp_f32 v4, v4
    v_exp_f32 v5, v5
    v_exp_f32 v6, v6
    v_exp_f32 v7, v7
    v_cvt_pk_bf16_f32 v0, v0, v1
    v_cvt_pk_bf16_f32 v1, v2, v3
    v_cvt_pk_bf16_f32 v2, v4, v5
    v_cvt_pk_bf16_f32 v3, v6, v7
    v_mfma_f32_32x32x8_bf16 v[16:31], v[88:89], v[74:75], v[16:31]
    ds_read_b128 v[76:79], v108 offset:10240
    v_exp_f32 v8, v8
    v_exp_f32 v9, v9
    v_exp_f32 v10, v10
    v_exp_f32 v11, v11
    v_mfma_f32_32x32x16_bf16 v[32:47], v[92:95], v[0:3], v[32:47]
    v_exp_f32 v12, v12
    v_exp_f32 v13, v13
    v_exp_f32 v14, v14
    v_exp_f32 v15, v15
    v_cvt_pk_bf16_f32 v8, v8, v9
    v_cvt_pk_bf16_f32 v9, v10, v11
    v_cvt_pk_bf16_f32 v10, v12, v13
    v_cvt_pk_bf16_f32 v11, v14, v15
    s_nop 1
    v_mfma_f32_32x32x16_bf16 v[32:47], v[96:99], v[8:11], v[32:47]
    v_exp_f32 v16, v16
    v_exp_f32 v17, v17
    v_exp_f32 v18, v18
    v_exp_f32 v19, v19
    v_mfma_f32_32x32x16_bf16 v[0:15], v[80:83], v[64:67], 0
    v_exp_f32 v20, v20
    v_exp_f32 v21, v21
    v_exp_f32 v22, v22
    v_exp_f32 v23, v23
    v_cvt_pk_bf16_f32 v16, v16, v17
    v_cvt_pk_bf16_f32 v17, v18, v19
    v_cvt_pk_bf16_f32 v18, v20, v21
    v_cvt_pk_bf16_f32 v19, v22, v23
    v_mfma_f32_32x32x8_bf16 v[0:15], v[90:91], v[72:73], v[0:15]
    v_exp_f32 v24, v24
    v_exp_f32 v25, v25
    v_exp_f32 v26, v26
    v_exp_f32 v27, v27
    v_mfma_f32_32x32x16_bf16 v[48:63], v[92:95], v[16:19], v[48:63]
    v_exp_f32 v28, v28
    v_exp_f32 v29, v29
    v_exp_f32 v30, v30
    v_exp_f32 v31, v31
    v_cvt_pk_bf16_f32 v24, v24, v25
    v_cvt_pk_bf16_f32 v25, v26, v27
    v_cvt_pk_bf16_f32 v26, v28, v29
    v_cvt_pk_bf16_f32 v27, v30, v31
    s_nop 0
    s_waitcnt lgkmcnt(0)
    v_mfma_f32_32x32x16_bf16 v[48:63], v[96:99], v[24:27], v[48:63]
    s_mov_b64 exec, s[22:23]
    ds_read_b128 v[92:95], v109 offset:12800
    ds_read_b128 v[96:99], v109 offset:13440
    s_mov_b64 exec, -1
    v_exp_f32 v0, v0
    v_exp_f32 v1, v1
    v_exp_f32 v2, v2
    v_exp_f32 v3, v3
    v_mfma_f32_32x32x16_bf16 v[16:31], v[80:83], v[68:71], 0
    v_exp_f32 v4, v4
    v_exp_f32 v5, v5
    v_exp_f32 v6, v6
    v_exp_f32 v7, v7
    v_cvt_pk_bf16_f32 v0, v0, v1
    v_cvt_pk_bf16_f32 v1, v2, v3
    v_cvt_pk_bf16_f32 v2, v4, v5
    v_cvt_pk_bf16_f32 v3, v6, v7
    v_mfma_f32_32x32x8_bf16 v[16:31], v[90:91], v[74:75], v[16:31]
    ds_read_b128 v[80:83], v108 offset:11264
    s_mov_b64 exec, s[20:21]
    ds_read_b128 v[88:91], v108 offset:17408
    s_mov_b64 exec, -1
    v_exp_f32 v8, v8
    v_exp_f32 v9, v9
    v_exp_f32 v10, v10
    v_exp_f32 v11, v11
    v_mfma_f32_32x32x16_bf16 v[32:47], v[100:103], v[0:3], v[32:47]
    v_exp_f32 v12, v12
    v_exp_f32 v13, v13
    v_exp_f32 v14, v14
    v_exp_f32 v15, v15
    v_cvt_pk_bf16_f32 v8, v8, v9
    v_cvt_pk_bf16_f32 v9, v10, v11
    v_cvt_pk_bf16_f32 v10, v12, v13
    v_cvt_pk_bf16_f32 v11, v14, v15
    s_nop 1
    v_mfma_f32_32x32x16_bf16 v[32:47], v[104:107], v[8:11], v[32:47]
    v_exp_f32 v16, v16
    v_exp_f32 v17, v17
    v_exp_f32 v18, v18
    v_exp_f32 v19, v19
    v_mfma_f32_32x32x16_bf16 v[0:15], v[76:79], v[64:67], 0
    v_exp_f32 v20, v20
    v_exp_f32 v21, v21
    v_exp_f32 v22, v22
    v_exp_f32 v23, v23
    v_cvt_pk_bf16_f32 v16, v16, v17
    v_cvt_pk_bf16_f32 v17, v18, v19
    v_cvt_pk_bf16_f32 v18, v20, v21
    v_cvt_pk_bf16_f32 v19, v22, v23
    v_mfma_f32_32x32x8_bf16 v[0:15], v[84:85], v[72:73], v[0:15]
    v_exp_f32 v24, v24
    v_exp_f32 v25, v25
    v_exp_f32 v26, v26
    v_exp_f32 v27, v27
    v_mfma_f32_32x32x16_bf16 v[48:63], v[100:103], v[16:19], v[48:63]
    v_exp_f32 v28, v28
    v_exp_f32 v29, v29
    v_exp_f32 v30, v30
    v_exp_f32 v31, v31
    v_cvt_pk_bf16_f32 v24, v24, v25
    v_cvt_pk_bf16_f32 v25, v26, v27
    v_cvt_pk_bf16_f32 v26, v28, v29
    v_cvt_pk_bf16_f32 v27, v30, v31
    s_nop 0
    s_waitcnt lgkmcnt(0)
    v_mfma_f32_32x32x16_bf16 v[48:63], v[104:107], v[24:27], v[48:63]
    s_mov_b64 exec, s[22:23]
    ds_read_b128 v[100:103], v109 offset:14080
    ds_read_b128 v[104:107], v109 offset:14720
    s_mov_b64 exec, -1
    v_exp_f32 v0, v0
    v_exp_f32 v1, v1
    v_exp_f32 v2, v2
    v_exp_f32 v3, v3
    v_mfma_f32_32x32x16_bf16 v[16:31], v[76:79], v[68:71], 0
    v_exp_f32 v4, v4
    v_exp_f32 v5, v5
    v_exp_f32 v6, v6
    v_exp_f32 v7, v7
    v_cvt_pk_bf16_f32 v0, v0, v1
    v_cvt_pk_bf16_f32 v1, v2, v3
    v_cvt_pk_bf16_f32 v2, v4, v5
    v_cvt_pk_bf16_f32 v3, v6, v7
    v_mfma_f32_32x32x8_bf16 v[16:31], v[84:85], v[74:75], v[16:31]
    ds_read_b128 v[76:79], v108 offset:15360
    v_exp_f32 v8, v8
    v_exp_f32 v9, v9
    v_exp_f32 v10, v10
    v_exp_f32 v11, v11
    v_mfma_f32_32x32x16_bf16 v[32:47], v[92:95], v[0:3], v[32:47]
    v_exp_f32 v12, v12
    v_exp_f32 v13, v13
    v_exp_f32 v14, v14
    v_exp_f32 v15, v15
    v_cvt_pk_bf16_f32 v8, v8, v9
    v_cvt_pk_bf16_f32 v9, v10, v11
    v_cvt_pk_bf16_f32 v10, v12, v13
    v_cvt_pk_bf16_f32 v11, v14, v15
    s_nop 1
    v_mfma_f32_32x32x16_bf16 v[32:47], v[96:99], v[8:11], v[32:47]
    v_exp_f32 v16, v16
    v_exp_f32 v17, v17
    v_exp_f32 v18, v18
    v_exp_f32 v19, v19
    v_mfma_f32_32x32x16_bf16 v[0:15], v[80:83], v[64:67], 0
    v_exp_f32 v20, v20
    v_exp_f32 v21, v21
    v_exp_f32 v22, v22
    v_exp_f32 v23, v23
    v_cvt_pk_bf16_f32 v16, v16, v17
    v_cvt_pk_bf16_f32 v17, v18, v19
    v_cvt_pk_bf16_f32 v18, v20, v21
    v_cvt_pk_bf16_f32 v19, v22, v23
    v_mfma_f32_32x32x8_bf16 v[0:15], v[86:87], v[72:73], v[0:15]
    v_exp_f32 v24, v24
    v_exp_f32 v25, v25
    v_exp_f32 v26, v26
    v_exp_f32 v27, v27
    v_mfma_f32_32x32x16_bf16 v[48:63], v[92:95], v[16:19], v[48:63]
    v_exp_f32 v28, v28
    v_exp_f32 v29, v29
    v_exp_f32 v30, v30
    v_exp_f32 v31, v31
    v_cvt_pk_bf16_f32 v24, v24, v25
    v_cvt_pk_bf16_f32 v25, v26, v27
    v_cvt_pk_bf16_f32 v26, v28, v29
    v_cvt_pk_bf16_f32 v27, v30, v31
    s_nop 0
    s_waitcnt lgkmcnt(0)
    v_mfma_f32_32x32x16_bf16 v[48:63], v[96:99], v[24:27], v[48:63]
    s_mov_b64 exec, s[22:23]
    ds_read_b128 v[92:95], v109 offset:17920
    ds_read_b128 v[96:99], v109 offset:18560
    s_mov_b64 exec, -1
    v_exp_f32 v0, v0
    v_exp_f32 v1, v1
    v_exp_f32 v2, v2
    v_exp_f32 v3, v3
    v_mfma_f32_32x32x16_bf16 v[16:31], v[80:83], v[68:71], 0
    v_exp_f32 v4, v4
    v_exp_f32 v5, v5
    v_exp_f32 v6, v6
    v_exp_f32 v7, v7
    v_cvt_pk_bf16_f32 v0, v0, v1
    v_cvt_pk_bf16_f32 v1, v2, v3
    v_cvt_pk_bf16_f32 v2, v4, v5
    v_cvt_pk_bf16_f32 v3, v6, v7
    v_mfma_f32_32x32x8_bf16 v[16:31], v[86:87], v[74:75], v[16:31]
    ds_read_b128 v[80:83], v108 offset:16384
    s_mov_b64 exec, s[20:21]
    ds_read_b128 v[84:87], v108 offset:22528
    s_mov_b64 exec, -1
    v_exp_f32 v8, v8
    v_exp_f32 v9, v9
    v_exp_f32 v10, v10
    v_exp_f32 v11, v11
    v_mfma_f32_32x32x16_bf16 v[32:47], v[100:103], v[0:3], v[32:47]
    v_exp_f32 v12, v12
    v_exp_f32 v13, v13
    v_exp_f32 v14, v14
    v_exp_f32 v15, v15
    v_cvt_pk_bf16_f32 v8, v8, v9
    v_cvt_pk_bf16_f32 v9, v10, v11
    v_cvt_pk_bf16_f32 v10, v12, v13
    v_cvt_pk_bf16_f32 v11, v14, v15
    s_nop 1
    v_mfma_f32_32x32x16_bf16 v[32:47], v[104:107], v[8:11], v[32:47]
    v_exp_f32 v16, v16
    v_exp_f32 v17, v17
    v_exp_f32 v18, v18
    v_exp_f32 v19, v19
    v_mfma_f32_32x32x16_bf16 v[0:15], v[76:79], v[64:67], 0
    v_exp_f32 v20, v20
    v_exp_f32 v21, v21
    v_exp_f32 v22, v22
    v_exp_f32 v23, v23
    v_cvt_pk_bf16_f32 v16, v16, v17
    v_cvt_pk_bf16_f32 v17, v18, v19
    v_cvt_pk_bf16_f32 v18, v20, v21
    v_cvt_pk_bf16_f32 v19, v22, v23
    v_mfma_f32_32x32x8_bf16 v[0:15], v[88:89], v[72:73], v[0:15]
    v_exp_f32 v24, v24
    v_exp_f32 v25, v25
    v_exp_f32 v26, v26
    v_exp_f32 v27, v27
    v_mfma_f32_32x32x16_bf16 v[48:63], v[100:103], v[16:19], v[48:63]
    v_exp_f32 v28, v28
    v_exp_f32 v29, v29
    v_exp_f32 v30, v30
    v_exp_f32 v31, v31
    v_cvt_pk_bf16_f32 v24, v24, v25
    v_cvt_pk_bf16_f32 v25, v26, v27
    v_cvt_pk_bf16_f32 v26, v28, v29
    v_cvt_pk_bf16_f32 v27, v30, v31
    s_nop 0
    s_waitcnt lgkmcnt(0)
    v_mfma_f32_32x32x16_bf16 v[48:63], v[104:107], v[24:27], v[48:63]
    s_mov_b64 exec, s[22:23]
    ds_read_b128 v[100:103], v109 offset:19200
    ds_read_b128 v[104:107], v109 offset:19840
    s_mov_b64 exec, -1
    v_exp_f32 v0, v0
    v_exp_f32 v1, v1
    v_exp_f32 v2, v2
    v_exp_f32 v3, v3
    v_mfma_f32_32x32x16_bf16 v[16:31], v[76:79], v[68:71], 0
    v_exp_f32 v4, v4
    v_exp_f32 v5, v5
    v_exp_f32 v6, v6
    v_exp_f32 v7, v7
    v_cvt_pk_bf16_f32 v0, v0, v1
    v_cvt_pk_bf16_f32 v1, v2, v3
    v_cvt_pk_bf16_f32 v2, v4, v5
    v_cvt_pk_bf16_f32 v3, v6, v7
    v_mfma_f32_32x32x8_bf16 v[16:31], v[88:89], v[74:75], v[16:31]
    ds_read_b128 v[76:79], v108 offset:20480
    v_exp_f32 v8, v8
    v_exp_f32 v9, v9
    v_exp_f32 v10, v10
    v_exp_f32 v11, v11
    v_mfma_f32_32x32x16_bf16 v[32:47], v[92:95], v[0:3], v[32:47]
    v_exp_f32 v12, v12
    v_exp_f32 v13, v13
    v_exp_f32 v14, v14
    v_exp_f32 v15, v15
    v_cvt_pk_bf16_f32 v8, v8, v9
    v_cvt_pk_bf16_f32 v9, v10, v11
    v_cvt_pk_bf16_f32 v10, v12, v13
    v_cvt_pk_bf16_f32 v11, v14, v15
    s_nop 1
    v_mfma_f32_32x32x16_bf16 v[32:47], v[96:99], v[8:11], v[32:47]
    v_exp_f32 v16, v16
    v_exp_f32 v17, v17
    v_exp_f32 v18, v18
    v_exp_f32 v19, v19
    v_mfma_f32_32x32x16_bf16 v[0:15], v[80:83], v[64:67], 0
    v_exp_f32 v20, v20
    v_exp_f32 v21, v21
    v_exp_f32 v22, v22
    v_exp_f32 v23, v23
    v_cvt_pk_bf16_f32 v16, v16, v17
    v_cvt_pk_bf16_f32 v17, v18, v19
    v_cvt_pk_bf16_f32 v18, v20, v21
    v_cvt_pk_bf16_f32 v19, v22, v23
    v_mfma_f32_32x32x8_bf16 v[0:15], v[90:91], v[72:73], v[0:15]
    v_exp_f32 v24, v24
    v_exp_f32 v25, v25
    v_exp_f32 v26, v26
    v_exp_f32 v27, v27
    v_mfma_f32_32x32x16_bf16 v[48:63], v[92:95], v[16:19], v[48:63]
    v_exp_f32 v28, v28
    v_exp_f32 v29, v29
    v_exp_f32 v30, v30
    v_exp_f32 v31, v31
    v_cvt_pk_bf16_f32 v24, v24, v25
    v_cvt_pk_bf16_f32 v25, v26, v27
    v_cvt_pk_bf16_f32 v26, v28, v29
    v_cvt_pk_bf16_f32 v27, v30, v31
    s_nop 0
    s_waitcnt lgkmcnt(0)
    v_mfma_f32_32x32x16_bf16 v[48:63], v[96:99], v[24:27], v[48:63]
    s_mov_b64 exec, s[22:23]
    ds_read_b128 v[92:95], v109 offset:23040
    ds_read_b128 v[96:99], v109 offset:23680
    s_mov_b64 exec, -1
    v_exp_f32 v0, v0
    v_exp_f32 v1, v1
    v_exp_f32 v2, v2
    v_exp_f32 v3, v3
    v_mfma_f32_32x32x16_bf16 v[16:31], v[80:83], v[68:71], 0
    v_exp_f32 v4, v4
    v_exp_f32 v5, v5
    v_exp_f32 v6, v6
    v_exp_f32 v7, v7
    v_cvt_pk_bf16_f32 v0, v0, v1
    v_cvt_pk_bf16_f32 v1, v2, v3
    v_cvt_pk_bf16_f32 v2, v4, v5
    v_cvt_pk_bf16_f32 v3, v6, v7
    v_mfma_f32_32x32x8_bf16 v[16:31], v[90:91], v[74:75], v[16:31]
    ds_read_b128 v[80:83], v108 offset:21504
    s_mov_b64 exec, s[20:21]
    ds_read_b128 v[88:91], v108 offset:27648
    s_mov_b64 exec, -1
    v_exp_f32 v8, v8
    v_exp_f32 v9, v9
    v_exp_f32 v10, v10
    v_exp_f32 v11, v11
    v_mfma_f32_32x32x16_bf16 v[32:47], v[100:103], v[0:3], v[32:47]
    v_exp_f32 v12, v12
    v_exp_f32 v13, v13
    v_exp_f32 v14, v14
    v_exp_f32 v15, v15
    v_cvt_pk_bf16_f32 v8, v8, v9
    v_cvt_pk_bf16_f32 v9, v10, v11
    v_cvt_pk_bf16_f32 v10, v12, v13
    v_cvt_pk_bf16_f32 v11, v14, v15
    s_nop 1
    v_mfma_f32_32x32x16_bf16 v[32:47], v[104:107], v[8:11], v[32:47]
    v_exp_f32 v16, v16
    v_exp_f32 v17, v17
    v_exp_f32 v18, v18
    v_exp_f32 v19, v19
    v_mfma_f32_32x32x16_bf16 v[0:15], v[76:79], v[64:67], 0
    v_exp_f32 v20, v20
    v_exp_f32 v21, v21
    v_exp_f32 v22, v22
    v_exp_f32 v23, v23
    v_cvt_pk_bf16_f32 v16, v16, v17
    v_cvt_pk_bf16_f32 v17, v18, v19
    v_cvt_pk_bf16_f32 v18, v20, v21
    v_cvt_pk_bf16_f32 v19, v22, v23
    v_mfma_f32_32x32x8_bf16 v[0:15], v[84:85], v[72:73], v[0:15]
    v_exp_f32 v24, v24
    v_exp_f32 v25, v25
    v_exp_f32 v26, v26
    v_exp_f32 v27, v27
    v_mfma_f32_32x32x16_bf16 v[48:63], v[100:103], v[16:19], v[48:63]
    v_exp_f32 v28, v28
    v_exp_f32 v29, v29
    v_exp_f32 v30, v30
    v_exp_f32 v31, v31
    v_cvt_pk_bf16_f32 v24, v24, v25
    v_cvt_pk_bf16_f32 v25, v26, v27
    v_cvt_pk_bf16_f32 v26, v28, v29
    v_cvt_pk_bf16_f32 v27, v30, v31
    s_nop 0
    s_cmp_lg_u32 s28, 5
    s_cbranch_scc1 L_attn_np
    s_setprio 0
L_attn_np:
    v_add_u32 v108, 20480, v108
    v_add_u32 v109, 20480, v109
    s_add_u32 s28, s28, 1
    s_cmp_lt_u32 s28, 7
    s_cbranch_scc1 L_attn_loop
    s_barrier
    s_waitcnt lgkmcnt(0)
    v_mfma_f32_32x32x16_bf16 v[48:63], v[104:107], v[24:27], v[48:63]
    s_mov_b64 exec, s[22:23]
    ds_read_b128 v[100:103], v109 offset:3840
    ds_read_b128 v[104:107], v109 offset:4480
    s_mov_b64 exec, -1
    v_exp_f32 v0, v0
    v_exp_f32 v1, v1
    v_exp_f32 v2, v2
    v_exp_f32 v3, v3
    v_mfma_f32_32x32x16_bf16 v[16:31], v[76:79], v[68:71], 0
    v_exp_f32 v4, v4
    v_exp_f32 v5, v5
    v_exp_f32 v6, v6
    v_exp_f32 v7, v7
    v_cvt_pk_bf16_f32 v0, v0, v1
    v_cvt_pk_bf16_f32 v1, v2, v3
    v_cvt_pk_bf16_f32 v2, v4, v5
    v_cvt_pk_bf16_f32 v3, v6, v7
    v_mfma_f32_32x32x8_bf16 v[16:31], v[84:85], v[74:75], v[16:31]
    ds_read_b128 v[76:79], v108 offset:5120
    v_exp_f32 v8, v8
    v_exp_f32 v9, v9
    v_exp_f32 v10, v10
    v_exp_f32 v11, v11
    v_mfma_f32_32x32x16_bf16 v[32:47], v[92:95], v[0:3], v[32:47]
    v_exp_f32 v12, v12
    v_exp_f32 v13, v13
    v_exp_f32 v14, v14
    v_exp_f32 v15, v15
    v_cvt_pk_bf16_f32 v8, v8, v9
    v_cvt_pk_bf16_f32 v9, v10, v11
    v_cvt_pk_bf16_f32 v10, v12, v13
    v_cvt_pk_bf16_f32 v11, v14, v15
    s_nop 1
    v_mfma_f32_32x32x16_bf16 v[32:47], v[96:99], v[8:11], v[32:47]
    v_exp_f32 v16, v16
    v_exp_f32 v17, v17
    v_exp_f32 v18, v18
    v_exp_f32 v19, v19
    v_mfma_f32_32x32x16_bf16 v[0:15], v[80:83], v[64:67], 0
    v_exp_f32 v20, v20
    v_exp_f32 v21, v21
    v_exp_f32 v22, v22
    v_exp_f32 v23, v23
    v_cvt_pk_bf16_f32 v16, v16, v17
    v_cvt_pk_bf16_f32 v17, v18, v19
    v_cvt_pk_bf16_f32 v18, v20, v21
    v_cvt_pk_bf16_f32 v19, v22, v23
    v_mfma_f32_32x32x8_bf16 v[0:15], v[86:87], v[72:73], v[0:15]
    v_exp_f32 v24, v24
    v_exp_f32 v25, v25
    v_exp_f32 v26, v26
    v_exp_f32 v27, v27
    v_mfma_f32_32x32x16_bf16 v[48:63], v[92:95], v[16:19], v[48:63]
    v_exp_f32 v28, v28
    v_exp_f32 v29, v29
    v_exp_f32 v30, v30
    v_exp_f32 v31, v31
    v_cvt_pk_bf16_f32 v24, v24, v25
    v_cvt_pk_bf16_f32 v25, v26, v27
    v_cvt_pk_bf16_f32 v26, v28, v29
    v_cvt_pk_bf16_f32 v27, v30, v31
    s_nop 0
    s_waitcnt lgkmcnt(0)
    v_mfma_f32_32x32x16_bf16 v[48:63], v[96:99], v[24:27], v[48:63]
    s_mov_b64 exec, s[22:23]
    ds_read_b128 v[92:95], v109 offset:7680
    ds_read_b128 v[96:99], v109 offset:8320
    s_mov_b64 exec, -1
    v_exp_f32 v0, v0
    v_exp_f32 v1, v1
    v_exp_f32 v2, v2
    v_exp_f32 v3, v3
    v_mfma_f32_32x32x16_bf16 v[16:31], v[80:83], v[68:71], 0
    v_exp_f32 v4, v4
    v_exp_f32 v5, v5
    v_exp_f32 v6, v6
    v_exp_f32 v7, v7
    v_cvt_pk_bf16_f32 v0, v0, v1
    v_cvt_pk_bf16_f32 v1, v2, v3
    v_cvt_pk_bf16_f32 v2, v4, v5
    v_cvt_pk_bf16_f32 v3, v6, v7
    v_mfma_f32_32x32x8_bf16 v[16:31], v[86:87], v[74:75], v[16:31]
    ds_read_b128 v[80:83], v108 offset:6144
    s_mov_b64 exec, s[20:21]
    ds_read_b128 v[84:87], v108 offset:12288
    s_mov_b64 exec, -1
    v_exp_f32 v8, v8
    v_exp_f32 v9, v9
    v_exp_f32 v10, v10
    v_exp_f32 v11, v11
    v_mfma_f32_32x32x16_bf16 v[32:47], v[100:103], v[0:3], v[32:47]
    v_exp_f32 v12, v12
    v_exp_f32 v13, v13
    v_exp_f32 v14, v14
    v_exp_f32 v15, v15
    v_cvt_pk_bf16_f32 v8, v8, v9
    v_cvt_pk_bf16_f32 v9, v10, v11
    v_cvt_pk_bf16_f32 v10, v12, v13
    v_cvt_pk_bf16_f32 v11, v14, v15
    s_nop 1
    v_mfma_f32_32x32x16_bf16 v[32:47], v[104:107], v[8:11], v[32:47]
    v_exp_f32 v16, v16
    v_exp_f32 v17, v17
    v_exp_f32 v18, v18
    v_exp_f32 v19, v19
    v_mfma_f32_32x32x16_bf16 v[0:15], v[76:79], v[64:67], 0
    v_exp_f32 v20, v20
    v_exp_f32 v21, v21
    v_exp_f32 v22, v22
    v_exp_f32 v23, v23
    v_cvt_pk_bf16_f32 v16, v16, v17
    v_cvt_pk_bf16_f32 v17, v18, v19
    v_cvt_pk_bf16_f32 v18, v20, v21
    v_cvt_pk_bf16_f32 v19, v22, v23
    v_mfma_f32_32x32x8_bf16 v[0:15], v[88:89], v[72:73], v[0:15]
    v_exp_f32 v24, v24
    v_exp_f32 v25, v25
    v_exp_f32 v26, v26
    v_exp_f32 v27, v27
    v_mfma_f32_32x32x16_bf16 v[48:63], v[100:103], v[16:19], v[48:63]
    v_exp_f32 v28, v28
    v_exp_f32 v29, v29
    v_exp_f32 v30, v30
    v_exp_f32 v31, v31
    v_cvt_pk_bf16_f32 v24, v24, v25
    v_cvt_pk_bf16_f32 v25, v26, v27
    v_cvt_pk_bf16_f32 v26, v28, v29
    v_cvt_pk_bf16_f32 v27, v30, v31
    s_nop 0
    s_waitcnt lgkmcnt(0)
    v_mfma_f32_32x32x16_bf16 v[48:63], v[104:107], v[24:27], v[48:63]
    s_mov_b64 exec, s[22:23]
    ds_read_b128 v[100:103], v109 offset:8960
    ds_read_b128 v[104:107], v109 offset:9600
    s_mov_b64 exec, -1
    v_exp_f32 v0, v0
    v_exp_f32 v1, v1
    v_exp_f32 v2, v2
    v_exp_f32 v3, v3
    v_mfma_f32_32x32x16_bf16 v[16:31], v[76:79], v[68:71], 0
    v_exp_f32 v4, v4
    v_exp_f32 v5, v5
    v_exp_f32 v6, v6
    v_exp_f32 v7, v7
    v_cvt_pk_bf16_f32 v0, v0, v1
    v_cvt_pk_bf16_f32 v1, v2, v3
    v_cvt_pk_bf16_f32 v2, v4, v5
    v_cvt_pk_bf16_f32 v3, v6, v7
    v_mfma_f32_32x32x8_bf16 v[16:31], v[88:89], v[74:75], v[16:31]
    ds_read_b128 v[76:79], v108 offset:10240
    v_exp_f32 v8, v8
    v_exp_f32 v9, v9
    v_exp_f32 v10, v10
    v_exp_f32 v11, v11
    v_mfma_f32_32x32x16_bf16 v[32:47], v[92:95], v[0:3], v[32:47]
    v_exp_f32 v12, v12
    v_exp_f32 v13, v13
    v_exp_f32 v14, v14
    v_exp_f32 v15, v15
    v_cvt_pk_bf16_f32 v8, v8, v9
    v_cvt_pk_bf16_f32 v9, v10, v11
    v_cvt_pk_bf16_f32 v10, v12, v13
    v_cvt_pk_bf16_f32 v11, v14, v15
    s_nop 1
    v_mfma_f32_32x32x16_bf16 v[32:47], v[96:99], v[8:11], v[32:47]
    v_exp_f32 v16, v16
    v_exp_f32 v17, v17
    v_exp_f32 v18, v18
    v_exp_f32 v19, v19
    v_mfma_f32_32x32x16_bf16 v[0:15], v[80:83], v[64:67], 0
    v_exp_f32 v20, v20
    v_exp_f32 v21, v21
    v_exp_f32 v22, v22
    v_exp_f32 v23, v23
    v_cvt_pk_bf16_f32 v16, v16, v17
    v_cvt_pk_bf16_f32 v17, v18, v19
    v_cvt_pk_bf16_f32 v18, v20, v21
    v_cvt_pk_bf16_f32 v19, v22, v23
    v_mfma_f32_32x32x8_bf16 v[0:15], v[90:91], v[72:73], v[0:15]
    v_exp_f32 v24, v24
    v_exp_f32 v25, v25
    v_exp_f32 v26, v26
    v_exp_f32 v27, v27
    v_mfma_f32_32x32x16_bf16 v[48:63], v[92:95], v[16:19], v[48:63]
    v_exp_f32 v28, v28
    v_exp_f32 v29, v29
    v_exp_f32 v30, v30
    v_exp_f32 v31, v31
    v_cvt_pk_bf16_f32 v24, v24, v25
    v_cvt_pk_bf16_f32 v25, v26, v27
    v_cvt_pk_bf16_f32 v26, v28, v29
    v_cvt_pk_bf16_f32 v27, v30, v31
    s_nop 0
    s_waitcnt lgkmcnt(0)
    v_mfma_f32_32x32x16_bf16 v[48:63], v[96:99], v[24:27], v[48:63]
    s_mov_b64 exec, s[22:23]
    ds_read_b128 v[92:95], v109 offset:12800
    ds_read_b128 v[96:99], v109 offset:13440
    s_mov_b64 exec, -1
    v_exp_f32 v0, v0
    v_exp_f32 v1, v1
    v_exp_f32 v2, v2
    v_exp_f32 v3, v3
    v_mfma_f32_32x32x16_bf16 v[16:31], v[80:83], v[68:71], 0
    v_exp_f32 v4, v4
    v_exp_f32 v5, v5
    v_exp_f32 v6, v6
    v_exp_f32 v7, v7
    v_cvt_pk_bf16_f32 v0, v0, v1
    v_cvt_pk_bf16_f32 v1, v2, v3
    v_cvt_pk_bf16_f32 v2, v4, v5
    v_cvt_pk_bf16_f32 v3, v6, v7
    v_mfma_f32_32x32x8_bf16 v[16:31], v[90:91], v[74:75], v[16:31]
    ds_read_b128 v[80:83], v108 offset:11264
    s_mov_b64 exec, s[20:21]
    ds_read_b128 v[88:91], v108 offset:17408
    s_mov_b64 exec, -1
    v_exp_f32 v8, v8
    v_exp_f32 v9, v9
    v_exp_f32 v10, v10
    v_exp_f32 v11, v11
    v_mfma_f32_32x32x16_bf16 v[32:47], v[100:103], v[0:3], v[32:47]
    v_exp_f32 v12, v12
    v_exp_f32 v13, v13
    v_exp_f32 v14, v14
    v_exp_f32 v15, v15
    v_cvt_pk_bf16_f32 v8, v8, v9
    v_cvt_pk_bf16_f32 v9, v10, v11
    v_cvt_pk_bf16_f32 v10, v12, v13
    v_cvt_pk_bf16_f32 v11, v14, v15
    s_nop 1
    v_mfma_f32_32x32x16_bf16 v[32:47], v[104:107], v[8:11], v[32:47]
    v_exp_f32 v16, v16
    v_exp_f32 v17, v17
    v_exp_f32 v18, v18
    v_exp_f32 v19, v19
    v_mfma_f32_32x32x16_bf16 v[0:15], v[76:79], v[64:67], 0
    v_exp_f32 v20, v20
    v_exp_f32 v21, v21
    v_exp_f32 v22, v22
    v_exp_f32 v23, v23
    v_cvt_pk_bf16_f32 v16, v16, v17
    v_cvt_pk_bf16_f32 v17, v18, v19
    v_cvt_pk_bf16_f32 v18, v20, v21
    v_cvt_pk_bf16_f32 v19, v22, v23
    v_mfma_f32_32x32x8_bf16 v[0:15], v[84:85], v[72:73], v[0:15]
    v_exp_f32 v24, v24
    v_exp_f32 v25, v25
    v_exp_f32 v26, v26
    v_exp_f32 v27, v27
    v_mfma_f32_32x32x16_bf16 v[48:63], v[100:103], v[16:19], v[48:63]
    v_exp_f32 v28, v28
    v_exp_f32 v29, v29
    v_exp_f32 v30, v30
    v_exp_f32 v31, v31
    v_cvt_pk_bf16_f32 v24, v24, v25
    v_cvt_pk_bf16_f32 v25, v26, v27
    v_cvt_pk_bf16_f32 v26, v28, v29
    v_cvt_pk_bf16_f32 v27, v30, v31
    s_nop 0
    s_waitcnt lgkmcnt(0)
    v_mfma_f32_32x32x16_bf16 v[48:63], v[104:107], v[24:27], v[48:63]
    s_mov_b64 exec, s[22:23]
    ds_read_b128 v[100:103], v109 offset:14080
    ds_read_b128 v[104:107], v109 offset:14720
    s_mov_b64 exec, -1
    v_exp_f32 v0, v0
    v_exp_f32 v1, v1
    v_exp_f32 v2, v2
    v_exp_f32 v3, v3
    v_mfma_f32_32x32x16_bf16 v[16:31], v[76:79], v[68:71], 0
    v_exp_f32 v4, v4
    v_exp_f32 v5, v5
    v_exp_f32 v6, v6
    v_exp_f32 v7, v7
    v_cvt_pk_bf16_f32 v0, v0, v1
    v_cvt_pk_bf16_f32 v1, v2, v3
    v_cvt_pk_bf16_f32 v2, v4, v5
    v_cvt_pk_bf16_f32 v3, v6, v7
    v_mfma_f32_32x32x8_bf16 v[16:31], v[84:85], v[74:75], v[16:31]
    ds_read_b128 v[76:79], v108 offset:15360
    v_exp_f32 v8, v8
    v_exp_f32 v9, v9
    v_exp_f32 v10, v10
    v_exp_f32 v11, v11
    v_mfma_f32_32x32x16_bf16 v[32:47], v[92:95], v[0:3], v[32:47]
    v_exp_f32 v12, v12
    v_exp_f32 v13, v13
    v_exp_f32 v14, v14
    v_exp_f32 v15, v15
    v_cvt_pk_bf16_f32 v8, v8, v9
    v_cvt_pk_bf16_f32 v9, v10, v11
    v_cvt_pk_bf16_f32 v10, v12, v13
    v_cvt_pk_bf16_f32 v11, v14, v15
    s_nop 1
    v_mfma_f32_32x32x16_bf16 v[32:47], v[96:99], v[8:11], v[32:47]
    v_exp_f32 v16, v16
    v_exp_f32 v17, v17
    v_exp_f32 v18, v18
    v_exp_f32 v19, v19
    v_mfma_f32_32x32x16_bf16 v[0:15], v[80:83], v[64:67], 0
    v_exp_f32 v20, v20
    v_exp_f32 v21, v21
    v_exp_f32 v22, v22
    v_exp_f32 v23, v23
    v_cvt_pk_bf16_f32 v16, v16, v17
    v_cvt_pk_bf16_f32 v17, v18, v19
    v_cvt_pk_bf16_f32 v18, v20, v21
    v_cvt_pk_bf16_f32 v19, v22, v23
    v_mfma_f32_32x32x8_bf16 v[0:15], v[86:87], v[72:73], v[0:15]
    v_exp_f32 v24, v24
    v_exp_f32 v25, v25
    v_exp_f32 v26, v26
    v_exp_f32 v27, v27
    v_mfma_f32_32x32x16_bf16 v[48:63], v[92:95], v[16:19], v[48:63]
    v_exp_f32 v28, v28
    v_exp_f32 v29, v29
    v_exp_f32 v30, v30
    v_exp_f32 v31, v31
    v_cvt_pk_bf16_f32 v24, v24, v25
    v_cvt_pk_bf16_f32 v25, v26, v27
    v_cvt_pk_bf16_f32 v26, v28, v29
    v_cvt_pk_bf16_f32 v27, v30, v31
    s_nop 0
    s_waitcnt lgkmcnt(0)
    v_mfma_f32_32x32x16_bf16 v[48:63], v[96:99], v[24:27], v[48:63]
    s_mov_b64 exec, s[22:23]
    ds_read_b128 v[92:95], v109 offset:17920
    ds_read_b128 v[96:99], v109 offset:18560
    s_mov_b64 exec, -1
    v_exp_f32 v0, v0
    v_exp_f32 v1, v1
    v_exp_f32 v2, v2
    v_exp_f32 v3, v3
    v_mfma_f32_32x32x16_bf16 v[16:31], v[80:83], v[68:71], 0
    v_exp_f32 v4, v4
    v_exp_f32 v5, v5
    v_exp_f32 v6, v6
    v_exp_f32 v7, v7
    v_cvt_pk_bf16_f32 v0, v0, v1
    v_cvt_pk_bf16_f32 v1, v2, v3
    v_cvt_pk_bf16_f32 v2, v4, v5
    v_cvt_pk_bf16_f32 v3, v6, v7
    v_mfma_f32_32x32x8_bf16 v[16:31], v[86:87], v[74:75], v[16:31]
    ds_read_b128 v[80:83], v108 offset:16384
    v_exp_f32 v8, v8
    v_exp_f32 v9, v9
    v_exp_f32 v10, v10
    v_exp_f32 v11, v11
    v_mfma_f32_32x32x16_bf16 v[32:47], v[100:103], v[0:3], v[32:47]
    v_exp_f32 v12, v12
    v_exp_f32 v13, v13
    v_exp_f32 v14, v14
    v_exp_f32 v15, v15
    v_cvt_pk_bf16_f32 v8, v8, v9
    v_cvt_pk_bf16_f32 v9, v10, v11
    v_cvt_pk_bf16_f32 v10, v12, v13
    v_cvt_pk_bf16_f32 v11, v14, v15
    s_nop 1
    v_mfma_f32_32x32x16_bf16 v[32:47], v[104:107], v[8:11], v[32:47]
    v_exp_f32 v16, v16
    v_exp_f32 v17, v17
    v_exp_f32 v18, v18
    v_exp_f32 v19, v19
    v_mfma_f32_32x32x16_bf16 v[0:15], v[76:79], v[64:67], 0
    v_exp_f32 v20, v20
    v_exp_f32 v21, v21
    v_exp_f32 v22, v22
    v_exp_f32 v23, v23
    v_cvt_pk_bf16_f32 v16, v16, v17
    v_cvt_pk_bf16_f32 v17, v18, v19
    v_cvt_pk_bf16_f32 v18, v20, v21
    v_cvt_pk_bf16_f32 v19, v22, v23
    v_mfma_f32_32x32x8_bf16 v[0:15], v[88:89], v[72:73], v[0:15]
    v_exp_f32 v24, v24
    v_exp_f32 v25, v25
    v_exp_f32 v26, v26
    v_exp_f32 v27, v27
    v_mfma_f32_32x32x16_bf16 v[48:63], v[100:103], v[16:19], v[48:63]
    v_exp_f32 v28, v28
    v_exp_f32 v29, v29
    v_exp_f32 v30, v30
    v_exp_f32 v31, v31
    v_cvt_pk_bf16_f32 v24, v24, v25
    v_cvt_pk_bf16_f32 v25, v26, v27
    v_cvt_pk_bf16_f32 v26, v28, v29
    v_cvt_pk_bf16_f32 v27, v30, v31
    s_nop 0
    s_waitcnt lgkmcnt(0)
    v_mfma_f32_32x32x16_bf16 v[48:63], v[104:107], v[24:27], v[48:63]
    s_mov_b64 exec, s[22:23]
    ds_read_b128 v[100:103], v109 offset:19200
    ds_read_b128 v[104:107], v109 offset:19840
    s_mov_b64 exec, -1
    v_exp_f32 v0, v0
    v_exp_f32 v1, v1
    v_exp_f32 v2, v2
    v_exp_f32 v3, v3
    v_mfma_f32_32x32x16_bf16 v[16:31], v[76:79], v[68:71], 0
    v_exp_f32 v4, v4
    v_exp_f32 v5, v5
    v_exp_f32 v6, v6
    v_exp_f32 v7, v7
    v_cvt_pk_bf16_f32 v0, v0, v1
    v_cvt_pk_bf16_f32 v1, v2, v3
    v_cvt_pk_bf16_f32 v2, v4, v5
    v_cvt_pk_bf16_f32 v3, v6, v7
    v_mfma_f32_32x32x8_bf16 v[16:31], v[88:89], v[74:75], v[16:31]
    v_exp_f32 v8, v8
    v_exp_f32 v9, v9
    v_exp_f32 v10, v10
    v_exp_f32 v11, v11
    v_mfma_f32_32x32x16_bf16 v[32:47], v[92:95], v[0:3], v[32:47]
    v_exp_f32 v12, v12
    v_exp_f32 v13, v13
    v_exp_f32 v14, v14
    v_exp_f32 v15, v15
    v_cvt_pk_bf16_f32 v8, v8, v9
    v_cvt_pk_bf16_f32 v9, v10, v11
    v_cvt_pk_bf16_f32 v10, v12, v13
    v_cvt_pk_bf16_f32 v11, v14, v15
    s_nop 1
    v_mfma_f32_32x32x16_bf16 v[32:47], v[96:99], v[8:11], v[32:47]
    v_exp_f32 v16, v16
    v_exp_f32 v17, v17
    v_exp_f32 v18, v18
    v_exp_f32 v19, v19
    v_mfma_f32_32x32x16_bf16 v[0:15], v[80:83], v[64:67], 0
    v_exp_f32 v20, v20
    v_exp_f32 v21, v21
    v_exp_f32 v22, v22
    v_exp_f32 v23, v23
    v_cvt_pk_bf16_f32 v16, v16, v17
    v_cvt_pk_bf16_f32 v17, v18, v19
    v_cvt_pk_bf16_f32 v18, v20, v21
    v_cvt_pk_bf16_f32 v19, v22, v23
    v_mfma_f32_32x32x8_bf16 v[0:15], v[90:91], v[72:73], v[0:15]
    v_exp_f32 v24, v24
    v_exp_f32 v25, v25
    v_exp_f32 v26, v26
    v_exp_f32 v27, v27
    v_mfma_f32_32x32x16_bf16 v[48:63], v[92:95], v[16:19], v[48:63]
    v_exp_f32 v28, v28
    v_exp_f32 v29, v29
    v_exp_f32 v30, v30
    v_exp_f32 v31, v31
    v_cvt_pk_bf16_f32 v24, v24, v25
    v_cvt_pk_bf16_f32 v25, v26, v27
    v_cvt_pk_bf16_f32 v26, v28, v29
    v_cvt_pk_bf16_f32 v27, v30, v31
    s_nop 0
    s_waitcnt lgkmcnt(0)
    v_mfma_f32_32x32x16_bf16 v[48:63], v[96:99], v[24:27], v[48:63]
    v_exp_f32 v0, v0
    v_exp_f32 v1, v1
    v_exp_f32 v2, v2
    v_exp_f32 v3, v3
    v_mfma_f32_32x32x16_bf16 v[16:31], v[80:83], v[68:71], 0
    v_exp_f32 v4, v4
    v_exp_f32 v5, v5
    v_exp_f32 v6, v6
    v_exp_f32 v7, v7
    v_cvt_pk_bf16_f32 v0, v0, v1
    v_cvt_pk_bf16_f32 v1, v2, v3
    v_cvt_pk_bf16_f32 v2, v4, v5
    v_cvt_pk_bf16_f32 v3, v6, v7
    v_mfma_f32_32x32x8_bf16 v[16:31], v[90:91], v[74:75], v[16:31]
    v_exp_f32 v8, v8
    v_exp_f32 v9, v9
    v_exp_f32 v10, v10
    v_exp_f32 v11, v11
    v_mfma_f32_32x32x16_bf16 v[32:47], v[100:103], v[0:3], v[32:47]
    v_exp_f32 v12, v12
    v_exp_f32 v13, v13
    v_exp_f32 v14, v14
    v_exp_f32 v15, v15
    v_cvt_pk_bf16_f32 v8, v8, v9
    v_cvt_pk_bf16_f32 v9, v10, v11
    v_cvt_pk_bf16_f32 v10, v12, v13
    v_cvt_pk_bf16_f32 v11, v14, v15
    s_nop 1
    v_mfma_f32_32x32x16_bf16 v[32:47], v[104:107], v[8:11], v[32:47]
    v_exp_f32 v16, v16
    v_exp_f32 v17, v17
    v_exp_f32 v18, v18
    v_exp_f32 v19, v19
    v_exp_f32 v20, v20
    v_exp_f32 v21, v21
    v_exp_f32 v22, v22
    v_exp_f32 v23, v23
    v_cvt_pk_bf16_f32 v16, v16, v17
    v_cvt_pk_bf16_f32 v17, v18, v19
    v_cvt_pk_bf16_f32 v18, v20, v21
    v_cvt_pk_bf16_f32 v19, v22, v23
    v_exp_f32 v24, v24
    v_exp_f32 v25, v25
    v_exp_f32 v26, v26
    v_exp_f32 v27, v27
    v_mfma_f32_32x32x16_bf16 v[48:63], v[100:103], v[16:19], v[48:63]
    v_exp_f32 v28, v28
    v_exp_f32 v29, v29
    v_exp_f32 v30, v30
    v_exp_f32 v31, v31
    v_cvt_pk_bf16_f32 v24, v24, v25
    v_cvt_pk_bf16_f32 v25, v26, v27
    v_cvt_pk_bf16_f32 v26, v28, v29
    v_cvt_pk_bf16_f32 v27, v30, v31
    s_nop 1
    v_mfma_f32_32x32x16_bf16 v[48:63], v[104:107], v[24:27], v[48:63]
L_attn_epi:
    s_nop 7
    s_nop 7
    s_mov_b64 vcc, 0
    v_cndmask_b32 v110, v40, v44, s[20:21]
    v_mov_b32 v111, 0
    v_fma_f32 v111, v32, 0, v111
    v_fma_f32 v111, v33, 0, v111
    v_fma_f32 v111, v34, 0, v111
    v_fma_f32 v111, v35, 0, v111
    v_fma_f32 v111, v36, 0, v111
    v_fma_f32 v111, v37, 0, v111
    v_fma_f32 v111, v38, 0, v111
    v_fma_f32 v111, v39, 0, v111
    v_fma_f32 v111, v40, 0, v111
    v_fma_f32 v111, v41, 0, v111
    v_fma_f32 v111, v42, 0, v111
    v_fma_f32 v111, v43, 0, v111
    s_mov_b32 s27, 0x5f800000
    v_cmp_ngt_f32 s[34:35], s27, v110
    s_or_b64 vcc, vcc, s[34:35]
    s_mov_b32 s27, 0x1f800000
    v_cmp_nlt_f32 s[34:35], s27, v110
    s_or_b64 vcc, vcc, s[34:35]
    v_cmp_u_f32 s[34:35], v111, v111
    s_or_b64 vcc, vcc, s[34:35]
    v_cndmask_b32 v112, v56, v60, s[20:21]
    v_mov_b32 v111, 0
    v_fma_f32 v111, v48, 0, v111
    v_fma_f32 v111, v49, 0, v111
    v_fma_f32 v111, v50, 0, v111
    v_fma_f32 v111, v51, 0, v111
    v_fma_f32 v111, v52, 0, v111
    v_fma_f32 v111, v53, 0, v111
    v_fma_f32 v111, v54, 0, v111
    v_fma_f32 v111, v55, 0, v111
    v_fma_f32 v111, v56, 0, v111
    v_fma_f32 v111, v57, 0, v111
    v_fma_f32 v111, v58, 0, v111
    v_fma_f32 v111, v59, 0, v111
    s_mov_b32 s27, 0x5f800000
    v_cmp_ngt_f32 s[34:35], s27, v112
    s_or_b64 vcc, vcc, s[34:35]
    s_mov_b32 s27, 0x1f800000
    v_cmp_nlt_f32 s[34:35], s27, v112
    s_or_b64 vcc, vcc, s[34:35]
    v_cmp_u_f32 s[34:35], v111, v111
    s_or_b64 vcc, vcc, s[34:35]
    s_cmp_lg_u32 s32, 0
    s_cbranch_scc1 L_attn_store
    s_cbranch_vccnz L_attn_slow
L_attn_store:
    v_rcp_f32 v110, v110
    v_mov_b32 v111, s30
    v_fmac_f32 v111, s31, v114
    v_mul_f32 v111, v110, v111
    v_mul_f32 v32, v32, v111
    v_mul_f32 v33, v33, v111
    v_mul_f32 v34, v34, v111
    v_mul_f32 v35, v35, v111
    v_mul_f32 v36, v36, v111
    v_mul_f32 v37, v37, v111
    v_mul_f32 v38, v38, v111
    v_mul_f32 v39, v39, v111
    v_mul_f32 v40, v40, v111
    v_mul_f32 v41, v41, v111
    v_mul_f32 v42, v42, v111
    v_mul_f32 v43, v43, v111
    v_cvt_pk_bf16_f32 v32, v32, v33
    v_cvt_pk_bf16_f32 v33, v34, v35
    v_cvt_pk_bf16_f32 v34, v36, v37
    v_cvt_pk_bf16_f32 v35, v38, v39
    v_cvt_pk_bf16_f32 v36, v40, v41
    v_cvt_pk_bf16_f32 v37, v42, v43
    buffer_store_dwordx4 v[32:35], v116, s[8:11], s36 offen sc1
    s_mov_b64 exec, s[20:21]
    buffer_store_dwordx2 v[36:37], v117, s[8:11], s37 offen sc1
    s_mov_b64 exec, -1
    s_add_u32 s36, s36, 2048
    s_add_u32 s37, s37, 2048
    v_rcp_f32 v112, v112
    v_mov_b32 v111, s30
    v_fmac_f32 v111, s31, v115
    v_mul_f32 v111, v112, v111
    v_mul_f32 v48, v48, v111
    v_mul_f32 v49, v49, v111
    v_mul_f32 v50, v50, v111
    v_mul_f32 v51, v51, v111
    v_mul_f32 v52, v52, v111
    v_mul_f32 v53, v53, v111
    v_mul_f32 v54, v54, v111
    v_mul_f32 v55, v55, v111
    v_mul_f32 v56, v56, v111
    v_mul_f32 v57, v57, v111
    v_mul_f32 v58, v58, v111
    v_mul_f32 v59, v59, v111
    v_cvt_pk_bf16_f32 v48, v48, v49
    v_cvt_pk_bf16_f32 v49, v50, v51
    v_cvt_pk_bf16_f32 v50, v52, v53
    v_cvt_pk_bf16_f32 v51, v54, v55
    v_cvt_pk_bf16_f32 v52, v56, v57
    v_cvt_pk_bf16_f32 v53, v58, v59
    buffer_store_dwordx4 v[48:51], v116, s[8:11], s36 offen sc1
    s_mov_b64 exec, s[20:21]
    buffer_store_dwordx2 v[52:53], v117, s[8:11], s37 offen sc1
    s_mov_b64 exec, -1
    v_mbcnt_lo_u32_b32 v140, -1, 0
    v_mbcnt_hi_u32_b32 v140, -1, v140
    v_lshlrev_b32 v141, 4, v140
    v_and_b32 v142, 7, v140
    v_mul_u32_u24 v142, 32, v142
    s_lshl_b32 s27, s26, 7
    s_and_b32 s33, s25, 7
    s_mul_i32 s33, s33, 32
    s_add_u32 s27, s27, s33
    s_add_u32 s27, s27, 18890752
    v_mov_b32 v143, 1
    v_mov_b32 v144, 0
    s_waitcnt vmcnt(0)
    s_mov_b64 exec, 1
    buffer_atomic_add v143, v144, s[8:11], s27 offen sc1
    s_mov_b64 exec, -1
    s_barrier
    s_lshr_b32 s38, s26, 4
    s_lshl_b32 s38, s38, 3
    s_and_b32 s27, s25, 7
    s_add_u32 s38, s38, s27
    s_lshr_b32 s39, s25, 3
    s_and_b32 s40, s24, 3
    s_lshr_b32 s41, s24, 2
    s_mov_b32 s12, s6
    s_and_b32 s13, s7, 0xffff
    s_mov_b32 s14, 2621440
    s_mov_b32 s15, 0x00020000
    s_mul_i32 s27, s41, 5120
    v_add_u32 v143, s27, v141
    v_add_u32 v144, 61440, v143
    v_add_u32 v145, 122880, v143
    v_mov_b32 v120, 0
    v_mov_b32 v121, 0
    v_mov_b32 v122, 0
    v_mov_b32 v123, 0
    v_mov_b32 v124, 0
    v_mov_b32 v125, 0
    v_mov_b32 v126, 0
    v_mov_b32 v127, 0
    v_mov_b32 v128, 0
    v_mov_b32 v129, 0
    v_mov_b32 v130, 0
    v_mov_b32 v131, 0
    v_mov_b32 v132, 0
    v_mov_b32 v133, 0
    v_mov_b32 v134, 0
    v_mov_b32 v135, 0
    v_mov_b32 v136, 0
    v_mov_b32 v137, 0
    v_mov_b32 v138, 0
    v_mov_b32 v139, 0
    s_lshl_b32 s29, s38, 2
    s_add_u32 s29, s29, s40
    s_lshl_b32 s29, s29, 10
    s_mul_i32 s27, s41, 2621440
    s_add_u32 s29, s29, s27
    s_add_u32 s29, s29, 12582912
    s_mul_i32 s42, s41, 20
    s_add_u32 s42, s42, s40
    s_mul_i32 s42, s42, 40960
    s_mul_i32 s27, s39, 5120
    s_add_u32 s42, s42, s27
    s_add_u32 s42, s42, 19922944
    s_mul_i32 s43, s40, 10240
    s_mul_i32 s27, s41, 5120
    s_add_u32 s43, s43, s27
    s_lshl_b32 s27, s38, 8
    s_add_u32 s27, s27, 18890752
    s_mov_b32 s28, 0
    s_barrier
L_attn_poll:
    buffer_load_dword v0, v142, s[8:11], s27 offen sc1
    s_waitcnt vmcnt(0)
    v_cmp_le_u32 vcc, 8, v0
    s_cmp_eq_u64 vcc, -1
    s_cbranch_scc1 L_attn_go
    s_sleep 2
    s_add_u32 s28, s28, 1
    s_cmp_lt_u32 s28, 0x100000
    s_cbranch_scc1 L_attn_poll
L_attn_go:
    ds_read_b128 v[80:83], v143 offset:0
    ds_read_b128 v[84:87], v143 offset:1024
    ds_read_b128 v[88:91], v143 offset:2048
    ds_read_b128 v[92:95], v143 offset:3072
    ds_read_b128 v[96:99], v143 offset:4096
    buffer_load_dwordx4 v[0:3], v141, s[8:11], s29 offen
    s_add_u32 s29, s29, 131072
    buffer_load_dwordx4 v[4:7], v141, s[8:11], s29 offen
    s_add_u32 s29, s29, 131072
    buffer_load_dwordx4 v[8:11], v141, s[8:11], s29 offen
    s_add_u32 s29, s29, 131072
    buffer_load_dwordx4 v[12:15], v141, s[8:11], s29 offen
    s_add_u32 s29, s29, 131072
    buffer_load_dwordx4 v[16:19], v141, s[8:11], s29 offen
    s_add_u32 s29, s29, 131072
    buffer_load_dwordx4 v[20:23], v141, s[8:11], s29 offen
    s_add_u32 s29, s29, 131072
    ds_read_b128 v[100:103], v143 offset:10240
    ds_read_b128 v[104:107], v143 offset:11264
    ds_read_b128 v[108:111], v143 offset:12288
    ds_read_b128 v[112:115], v143 offset:13312
    ds_read_b128 v[116:119], v143 offset:14336
    s_waitcnt vmcnt(5) lgkmcnt(5)
    v_mfma_f32_16x16x32_bf16 v[120:123], v[80:83], v[0:3], v[120:123]
    v_mfma_f32_16x16x32_bf16 v[124:127], v[84:87], v[0:3], v[124:127]
    v_mfma_f32_16x16x32_bf16 v[128:131], v[88:91], v[0:3], v[128:131]
    v_mfma_f32_16x16x32_bf16 v[132:135], v[92:95], v[0:3], v[132:135]
    v_mfma_f32_16x16x32_bf16 v[136:139], v[96:99], v[0:3], v[136:139]
    buffer_load_dwordx4 v[24:27], v141, s[8:11], s29 offen
    s_add_u32 s29, s29, 131072
    ds_read_b128 v[80:83], v143 offset:20480
    ds_read_b128 v[84:87], v143 offset:21504
    ds_read_b128 v[88:91], v143 offset:22528
    ds_read_b128 v[92:95], v143 offset:23552
    ds_read_b128 v[96:99], v143 offset:24576
    s_waitcnt vmcnt(5) lgkmcnt(5)
    v_mfma_f32_16x16x32_bf16 v[120:123], v[100:103], v[4:7], v[120:123]
    v_mfma_f32_16x16x32_bf16 v[124:127], v[104:107], v[4:7], v[124:127]
    v_mfma_f32_16x16x32_bf16 v[128:131], v[108:111], v[4:7], v[128:131]
    v_mfma_f32_16x16x32_bf16 v[132:135], v[112:115], v[4:7], v[132:135]
    v_mfma_f32_16x16x32_bf16 v[136:139], v[116:119], v[4:7], v[136:139]
    buffer_load_dwordx4 v[28:31], v141, s[8:11], s29 offen
    s_add_u32 s29, s29, 131072
    ds_read_b128 v[100:103], v143 offset:30720
    ds_read_b128 v[104:107], v143 offset:31744
    ds_read_b128 v[108:111], v143 offset:32768
    ds_read_b128 v[112:115], v143 offset:33792
    ds_read_b128 v[116:119], v143 offset:34816
    s_waitcnt vmcnt(5) lgkmcnt(5)
    v_mfma_f32_16x16x32_bf16 v[120:123], v[80:83], v[8:11], v[120:123]
    v_mfma_f32_16x16x32_bf16 v[124:127], v[84:87], v[8:11], v[124:127]
    v_mfma_f32_16x16x32_bf16 v[128:131], v[88:91], v[8:11], v[128:131]
    v_mfma_f32_16x16x32_bf16 v[132:135], v[92:95], v[8:11], v[132:135]
    v_mfma_f32_16x16x32_bf16 v[136:139], v[96:99], v[8:11], v[136:139]
    buffer_load_dwordx4 v[32:35], v141, s[8:11], s29 offen
    s_add_u32 s29, s29, 131072
    ds_read_b128 v[80:83], v143 offset:40960
    ds_read_b128 v[84:87], v143 offset:41984
    ds_read_b128 v[88:91], v143 offset:43008
    ds_read_b128 v[92:95], v143 offset:44032
    ds_read_b128 v[96:99], v143 offset:45056
    s_waitcnt vmcnt(5) lgkmcnt(5)
    v_mfma_f32_16x16x32_bf16 v[120:123], v[100:103], v[12:15], v[120:123]
    v_mfma_f32_16x16x32_bf16 v[124:127], v[104:107], v[12:15], v[124:127]
    v_mfma_f32_16x16x32_bf16 v[128:131], v[108:111], v[12:15], v[128:131]
    v_mfma_f32_16x16x32_bf16 v[132:135], v[112:115], v[12:15], v[132:135]
    v_mfma_f32_16x16x32_bf16 v[136:139], v[116:119], v[12:15], v[136:139]
    s_barrier
    s_add_u32 m0, s43, 0
    s_add_u32 s27, s42, 655360
    buffer_load_dwordx4 v141, s[8:11], s27 offen offset:0 lds
    buffer_load_dwordx4 v141, s[8:11], s27 offen offset:1024 lds
    buffer_load_dwordx4 v141, s[8:11], s27 offen offset:2048 lds
    buffer_load_dwordx4 v141, s[8:11], s27 offen offset:3072 lds
    s_add_u32 m0, s43, 4096
    s_add_u32 s27, s27, 4096
    buffer_load_dwordx4 v141, s[8:11], s27 offen lds
    buffer_load_dwordx4 v[36:39], v141, s[8:11], s29 offen
    s_add_u32 s29, s29, 131072
    ds_read_b128 v[100:103], v143 offset:51200
    ds_read_b128 v[104:107], v143 offset:52224
    ds_read_b128 v[108:111], v143 offset:53248
    ds_read_b128 v[112:115], v143 offset:54272
    ds_read_b128 v[116:119], v143 offset:55296
    s_waitcnt vmcnt(10) lgkmcnt(5)
    v_mfma_f32_16x16x32_bf16 v[120:123], v[80:83], v[16:19], v[120:123]
    v_mfma_f32_16x16x32_bf16 v[124:127], v[84:87], v[16:19], v[124:127]
    v_mfma_f32_16x16x32_bf16 v[128:131], v[88:91], v[16:19], v[128:131]
    v_mfma_f32_16x16x32_bf16 v[132:135], v[92:95], v[16:19], v[132:135]
    v_mfma_f32_16x16x32_bf16 v[136:139], v[96:99], v[16:19], v[136:139]
    buffer_load_dwordx4 v[40:43], v141, s[8:11], s29 offen
    s_add_u32 s29, s29, 131072
    ds_read_b128 v[80:83], v144 offset:0
    ds_read_b128 v[84:87], v144 offset:1024
    ds_read_b128 v[88:91], v144 offset:2048
    ds_read_b128 v[92:95], v144 offset:3072
    ds_read_b128 v[96:99], v144 offset:4096
    s_waitcnt vmcnt(10) lgkmcnt(5)
    v_mfma_f32_16x16x32_bf16 v[120:123], v[100:103], v[20:23], v[120:123]
    v_mfma_f32_16x16x32_bf16 v[124:127], v[104:107], v[20:23], v[124:127]
    v_mfma_f32_16x16x32_bf16 v[128:131], v[108:111], v[20:23], v[128:131]
    v_mfma_f32_16x16x32_bf16 v[132:135], v[112:115], v[20:23], v[132:135]
    v_mfma_f32_16x16x32_bf16 v[136:139], v[116:119], v[20:23], v[136:139]
    buffer_load_dwordx4 v[44:47], v141, s[8:11], s29 offen
    s_add_u32 s29, s29, 131072
    ds_read_b128 v[100:103], v144 offset:10240
    ds_read_b128 v[104:107], v144 offset:11264
    ds_read_b128 v[108:111], v144 offset:12288
    ds_read_b128 v[112:115], v144 offset:13312
    ds_read_b128 v[116:119], v144 offset:14336
    s_waitcnt vmcnt(10) lgkmcnt(5)
    v_mfma_f32_16x16x32_bf16 v[120:123], v[80:83], v[24:27], v[120:123]
    v_mfma_f32_16x16x32_bf16 v[124:127], v[84:87], v[24:27], v[124:127]
    v_mfma_f32_16x16x32_bf16 v[128:131], v[88:91], v[24:27], v[128:131]
    v_mfma_f32_16x16x32_bf16 v[132:135], v[92:95], v[24:27], v[132:135]
    v_mfma_f32_16x16x32_bf16 v[136:139], v[96:99], v[24:27], v[136:139]
    buffer_load_dwordx4 v[48:51], v141, s[8:11], s29 offen
    s_add_u32 s29, s29, 131072
    ds_read_b128 v[80:83], v144 offset:20480
    ds_read_b128 v[84:87], v144 offset:21504
    ds_read_b128 v[88:91], v144 offset:22528
    ds_read_b128 v[92:95], v144 offset:23552
    ds_read_b128 v[96:99], v144 offset:24576
    s_waitcnt vmcnt(10) lgkmcnt(5)
    v_mfma_f32_16x16x32_bf16 v[120:123], v[100:103], v[28:31], v[120:123]
    v_mfma_f32_16x16x32_bf16 v[124:127], v[104:107], v[28:31], v[124:127]
    v_mfma_f32_16x16x32_bf16 v[128:131], v[108:111], v[28:31], v[128:131]
    v_mfma_f32_16x16x32_bf16 v[132:135], v[112:115], v[28:31], v[132:135]
    v_mfma_f32_16x16x32_bf16 v[136:139], v[116:119], v[28:31], v[136:139]
    buffer_load_dwordx4 v[52:55], v141, s[8:11], s29 offen
    s_add_u32 s29, s29, 131072
    ds_read_b128 v[100:103], v144 offset:30720
    ds_read_b128 v[104:107], v144 offset:31744
    ds_read_b128 v[108:111], v144 offset:32768
    ds_read_b128 v[112:115], v144 offset:33792
    ds_read_b128 v[116:119], v144 offset:34816
    s_waitcnt vmcnt(10) lgkmcnt(5)
    v_mfma_f32_16x16x32_bf16 v[120:123], v[80:83], v[32:35], v[120:123]
    v_mfma_f32_16x16x32_bf16 v[124:127], v[84:87], v[32:35], v[124:127]
    v_mfma_f32_16x16x32_bf16 v[128:131], v[88:91], v[32:35], v[128:131]
    v_mfma_f32_16x16x32_bf16 v[132:135], v[92:95], v[32:35], v[132:135]
    v_mfma_f32_16x16x32_bf16 v[136:139], v[96:99], v[32:35], v[136:139]
    buffer_load_dwordx4 v[56:59], v141, s[8:11], s29 offen
    s_add_u32 s29, s29, 131072
    ds_read_b128 v[80:83], v144 offset:40960
    ds_read_b128 v[84:87], v144 offset:41984
    ds_read_b128 v[88:91], v144 offset:43008
    ds_read_b128 v[92:95], v144 offset:44032
    ds_read_b128 v[96:99], v144 offset:45056
    s_waitcnt vmcnt(5) lgkmcnt(5)
    v_mfma_f32_16x16x32_bf16 v[120:123], v[100:103], v[36:39], v[120:123]
    v_mfma_f32_16x16x32_bf16 v[124:127], v[104:107], v[36:39], v[124:127]
    v_mfma_f32_16x16x32_bf16 v[128:131], v[108:111], v[36:39], v[128:131]
    v_mfma_f32_16x16x32_bf16 v[132:135], v[112:115], v[36:39], v[132:135]
    v_mfma_f32_16x16x32_bf16 v[136:139], v[116:119], v[36:39], v[136:139]
    buffer_load_dwordx4 v[60:63], v141, s[8:11], s29 offen
    s_add_u32 s29, s29, 131072
    ds_read_b128 v[100:103], v144 offset:51200
    ds_read_b128 v[104:107], v144 offset:52224
    ds_read_b128 v[108:111], v144 offset:53248
    ds_read_b128 v[112:115], v144 offset:54272
    ds_read_b128 v[116:119], v144 offset:55296
    s_waitcnt vmcnt(5) lgkmcnt(5)
    v_mfma_f32_16x16x32_bf16 v[120:123], v[80:83], v[40:43], v[120:123]
    v_mfma_f32_16x16x32_bf16 v[124:127], v[84:87], v[40:43], v[124:127]
    v_mfma_f32_16x16x32_bf16 v[128:131], v[88:91], v[40:43], v[128:131]
    v_mfma_f32_16x16x32_bf16 v[132:135], v[92:95], v[40:43], v[132:135]
    v_mfma_f32_16x16x32_bf16 v[136:139], v[96:99], v[40:43], v[136:139]
    buffer_load_dwordx4 v[64:67], v141, s[8:11], s29 offen
    s_add_u32 s29, s29, 131072
    ds_read_b128 v[80:83], v145 offset:0
    ds_read_b128 v[84:87], v145 offset:1024
    ds_read_b128 v[88:91], v145 offset:2048
    ds_read_b128 v[92:95], v145 offset:3072
    ds_read_b128 v[96:99], v145 offset:4096
    s_waitcnt vmcnt(5) lgkmcnt(5)
    v_mfma_f32_16x16x32_bf16 v[120:123], v[100:103], v[44:47], v[120:123]
    v_mfma_f32_16x16x32_bf16 v[124:127], v[104:107], v[44:47], v[124:127]
    v_mfma_f32_16x16x32_bf16 v[128:131], v[108:111], v[44:47], v[128:131]
    v_mfma_f32_16x16x32_bf16 v[132:135], v[112:115], v[44:47], v[132:135]
    v_mfma_f32_16x16x32_bf16 v[136:139], v[116:119], v[44:47], v[136:139]
    buffer_load_dwordx4 v[68:71], v141, s[8:11], s29 offen
    s_add_u32 s29, s29, 131072
    ds_read_b128 v[100:103], v145 offset:10240
    ds_read_b128 v[104:107], v145 offset:11264
    ds_read_b128 v[108:111], v145 offset:12288
    ds_read_b128 v[112:115], v145 offset:13312
    ds_read_b128 v[116:119], v145 offset:14336
    s_waitcnt vmcnt(5) lgkmcnt(5)
    v_mfma_f32_16x16x32_bf16 v[120:123], v[80:83], v[48:51], v[120:123]
    v_mfma_f32_16x16x32_bf16 v[124:127], v[84:87], v[48:51], v[124:127]
    v_mfma_f32_16x16x32_bf16 v[128:131], v[88:91], v[48:51], v[128:131]
    v_mfma_f32_16x16x32_bf16 v[132:135], v[92:95], v[48:51], v[132:135]
    v_mfma_f32_16x16x32_bf16 v[136:139], v[96:99], v[48:51], v[136:139]
    buffer_load_dwordx4 v[72:75], v141, s[8:11], s29 offen
    s_add_u32 s29, s29, 131072
    ds_read_b128 v[80:83], v145 offset:20480
    ds_read_b128 v[84:87], v145 offset:21504
    ds_read_b128 v[88:91], v145 offset:22528
    ds_read_b128 v[92:95], v145 offset:23552
    ds_read_b128 v[96:99], v145 offset:24576
    s_waitcnt vmcnt(5) lgkmcnt(5)
    v_mfma_f32_16x16x32_bf16 v[120:123], v[100:103], v[52:55], v[120:123]
    v_mfma_f32_16x16x32_bf16 v[124:127], v[104:107], v[52:55], v[124:127]
    v_mfma_f32_16x16x32_bf16 v[128:131], v[108:111], v[52:55], v[128:131]
    v_mfma_f32_16x16x32_bf16 v[132:135], v[112:115], v[52:55], v[132:135]
    v_mfma_f32_16x16x32_bf16 v[136:139], v[116:119], v[52:55], v[136:139]
    buffer_load_dwordx4 v[76:79], v141, s[8:11], s29 offen
    ds_read_b128 v[100:103], v145 offset:30720
    ds_read_b128 v[104:107], v145 offset:31744
    ds_read_b128 v[108:111], v145 offset:32768
    ds_read_b128 v[112:115], v145 offset:33792
    ds_read_b128 v[116:119], v145 offset:34816
    s_waitcnt vmcnt(5) lgkmcnt(5)
    v_mfma_f32_16x16x32_bf16 v[120:123], v[80:83], v[56:59], v[120:123]
    v_mfma_f32_16x16x32_bf16 v[124:127], v[84:87], v[56:59], v[124:127]
    v_mfma_f32_16x16x32_bf16 v[128:131], v[88:91], v[56:59], v[128:131]
    v_mfma_f32_16x16x32_bf16 v[132:135], v[92:95], v[56:59], v[132:135]
    v_mfma_f32_16x16x32_bf16 v[136:139], v[96:99], v[56:59], v[136:139]
    s_waitcnt vmcnt(4) lgkmcnt(0)
    v_mfma_f32_16x16x32_bf16 v[120:123], v[100:103], v[60:63], v[120:123]
    v_mfma_f32_16x16x32_bf16 v[124:127], v[104:107], v[60:63], v[124:127]
    v_mfma_f32_16x16x32_bf16 v[128:131], v[108:111], v[60:63], v[128:131]
    v_mfma_f32_16x16x32_bf16 v[132:135], v[112:115], v[60:63], v[132:135]
    v_mfma_f32_16x16x32_bf16 v[136:139], v[116:119], v[60:63], v[136:139]
    s_waitcnt vmcnt(11)
    s_barrier
    ds_read_b128 v[80:83], v143 offset:0
    ds_read_b128 v[84:87], v143 offset:1024
    ds_read_b128 v[88:91], v143 offset:2048
    ds_read_b128 v[92:95], v143 offset:3072
    ds_read_b128 v[96:99], v143 offset:4096
    ds_read_b128 v[100:103], v143 offset:10240
    ds_read_b128 v[104:107], v143 offset:11264
    ds_read_b128 v[108:111], v143 offset:12288
    ds_read_b128 v[112:115], v143 offset:13312
    ds_read_b128 v[116:119], v143 offset:14336
    s_waitcnt vmcnt(3) lgkmcnt(5)
    v_mfma_f32_16x16x32_bf16 v[120:123], v[80:83], v[64:67], v[120:123]
    v_mfma_f32_16x16x32_bf16 v[124:127], v[84:87], v[64:67], v[124:127]
    v_mfma_f32_16x16x32_bf16 v[128:131], v[88:91], v[64:67], v[128:131]
    v_mfma_f32_16x16x32_bf16 v[132:135], v[92:95], v[64:67], v[132:135]
    v_mfma_f32_16x16x32_bf16 v[136:139], v[96:99], v[64:67], v[136:139]
    ds_read_b128 v[80:83], v143 offset:20480
    ds_read_b128 v[84:87], v143 offset:21504
    ds_read_b128 v[88:91], v143 offset:22528
    ds_read_b128 v[92:95], v143 offset:23552
    ds_read_b128 v[96:99], v143 offset:24576
    s_waitcnt vmcnt(2) lgkmcnt(5)
    v_mfma_f32_16x16x32_bf16 v[120:123], v[100:103], v[68:71], v[120:123]
    v_mfma_f32_16x16x32_bf16 v[124:127], v[104:107], v[68:71], v[124:127]
    v_mfma_f32_16x16x32_bf16 v[128:131], v[108:111], v[68:71], v[128:131]
    v_mfma_f32_16x16x32_bf16 v[132:135], v[112:115], v[68:71], v[132:135]
    v_mfma_f32_16x16x32_bf16 v[136:139], v[116:119], v[68:71], v[136:139]
    ds_read_b128 v[100:103], v143 offset:30720
    ds_read_b128 v[104:107], v143 offset:31744
    ds_read_b128 v[108:111], v143 offset:32768
    ds_read_b128 v[112:115], v143 offset:33792
    ds_read_b128 v[116:119], v143 offset:34816
    s_waitcnt vmcnt(1) lgkmcnt(5)
    v_mfma_f32_16x16x32_bf16 v[120:123], v[80:83], v[72:75], v[120:123]
    v_mfma_f32_16x16x32_bf16 v[124:127], v[84:87], v[72:75], v[124:127]
    v_mfma_f32_16x16x32_bf16 v[128:131], v[88:91], v[72:75], v[128:131]
    v_mfma_f32_16x16x32_bf16 v[132:135], v[92:95], v[72:75], v[132:135]
    v_mfma_f32_16x16x32_bf16 v[136:139], v[96:99], v[72:75], v[136:139]
    s_waitcnt vmcnt(0) lgkmcnt(0)
    v_mfma_f32_16x16x32_bf16 v[120:123], v[100:103], v[76:79], v[120:123]
    v_mfma_f32_16x16x32_bf16 v[124:127], v[104:107], v[76:79], v[124:127]
    v_mfma_f32_16x16x32_bf16 v[128:131], v[108:111], v[76:79], v[128:131]
    v_mfma_f32_16x16x32_bf16 v[132:135], v[112:115], v[76:79], v[132:135]
    v_mfma_f32_16x16x32_bf16 v[136:139], v[116:119], v[76:79], v[136:139]
    s_mul_i32 s27, s40, 5120
    s_add_u32 s27, s27, 51200
    v_add_u32 v143, s27, v141
    s_cmp_eq_u32 s41, 0
    s_cbranch_scc1 L_attn_fin
    s_nop 4
    ds_write_b128 v143, v[120:123] offset:0
    ds_write_b128 v143, v[124:127] offset:1024
    ds_write_b128 v143, v[128:131] offset:2048
    ds_write_b128 v143, v[132:135] offset:3072
    ds_write_b128 v143, v[136:139] offset:4096
    s_waitcnt lgkmcnt(0)
    s_barrier
    s_endpgm
L_attn_fin:
    v_and_b32 v142, 15, v140
    v_mul_u32_u24 v142, 1280, v142
    v_lshrrev_b32 v141, 4, v140
    v_lshl_add_u32 v142, v141, 3, v142
    s_lshl_b32 s27, s38, 2
    s_add_u32 s27, s27, s40
    s_mul_i32 s27, s27, 20480
    s_mul_i32 s33, s39, 160
    s_add_u32 s27, s27, s33
    s_barrier
    ds_read_b128 v[0:3], v143 offset:0
    ds_read_b128 v[4:7], v143 offset:1024
    ds_read_b128 v[8:11], v143 offset:2048
    ds_read_b128 v[12:15], v143 offset:3072
    ds_read_b128 v[16:19], v143 offset:4096
    s_waitcnt lgkmcnt(4)
    v_add_f32 v0, v0, v120
    v_add_f32 v1, v1, v121
    v_add_f32 v2, v2, v122
    v_add_f32 v3, v3, v123
    v_cvt_pk_bf16_f32 v0, v0, v1
    v_cvt_pk_bf16_f32 v1, v2, v3
    buffer_store_dwordx2 v[0:1], v142, s[12:15], s27 offen offset:0
    s_waitcnt lgkmcnt(3)
    v_add_f32 v4, v4, v124
    v_add_f32 v5, v5, v125
    v_add_f32 v6, v6, v126
    v_add_f32 v7, v7, v127
    v_cvt_pk_bf16_f32 v4, v4, v5
    v_cvt_pk_bf16_f32 v5, v6, v7
    buffer_store_dwordx2 v[4:5], v142, s[12:15], s27 offen offset:32
    s_waitcnt lgkmcnt(2)
    v_add_f32 v8, v8, v128
    v_add_f32 v9, v9, v129
    v_add_f32 v10, v10, v130
    v_add_f32 v11, v11, v131
    v_cvt_pk_bf16_f32 v8, v8, v9
    v_cvt_pk_bf16_f32 v9, v10, v11
    buffer_store_dwordx2 v[8:9], v142, s[12:15], s27 offen offset:64
    s_waitcnt lgkmcnt(1)
    v_add_f32 v12, v12, v132
    v_add_f32 v13, v13, v133
    v_add_f32 v14, v14, v134
    v_add_f32 v15, v15, v135
    v_cvt_pk_bf16_f32 v12, v12, v13
    v_cvt_pk_bf16_f32 v13, v14, v15
    buffer_store_dwordx2 v[12:13], v142, s[12:15], s27 offen offset:96
    s_waitcnt lgkmcnt(0)
    v_add_f32 v16, v16, v136
    v_add_f32 v17, v17, v137
    v_add_f32 v18, v18, v138
    v_add_f32 v19, v19, v139
    v_cvt_pk_bf16_f32 v16, v16, v17
    v_cvt_pk_bf16_f32 v17, v18, v19
    buffer_store_dwordx2 v[16:17], v142, s[12:15], s27 offen offset:128
L_attn_done:
    s_endpgm
L_attn_slow:
    s_mov_b32 s32, 1
    s_not_b64 exec, s[20:21]
    v_mov_b32 v72, 0
    v_mov_b32 v73, 0
    v_mov_b32 v74, 0
    v_mov_b32 v75, 0
    s_mov_b64 exec, -1
    s_min_u32 s33, s25, 32
    s_mul_i32 s33, s33, 163840
    v_subrev_u32 v108, 143360, v108
    v_subrev_u32 v109, 143360, v109
    v_mov_b32 v110, 0xff800000
    v_mov_b32 v112, 0xff800000
    s_mov_b32 s28, 0
L_attn_slow0:
    s_mov_b64 exec, s[20:21]
    buffer_load_dwordx4 v[84:87], v108, s[8:11], s33 offen offset:2048
    s_mov_b64 exec, -1
    buffer_load_dwordx4 v[76:79], v108, s[8:11], s33 offen offset:0
    s_waitcnt vmcnt(0)
    v_mfma_f32_32x32x16_bf16 v[0:15], v[76:79], v[64:67], 0
    v_mfma_f32_32x32x8_bf16 v[0:15], v[84:85], v[72:73], v[0:15]
    v_mfma_f32_32x32x16_bf16 v[16:31], v[76:79], v[68:71], 0
    v_mfma_f32_32x32x8_bf16 v[16:31], v[84:85], v[74:75], v[16:31]
    s_nop 7
    s_nop 7
    v_max3_f32 v110, v110, v0, v1
    v_max3_f32 v110, v110, v2, v3
    v_max3_f32 v110, v110, v4, v5
    v_max3_f32 v110, v110, v6, v7
    v_max3_f32 v110, v110, v8, v9
    v_max3_f32 v110, v110, v10, v11
    v_max3_f32 v110, v110, v12, v13
    v_max3_f32 v110, v110, v14, v15
    v_max3_f32 v112, v112, v16, v17
    v_max3_f32 v112, v112, v18, v19
    v_max3_f32 v112, v112, v20, v21
    v_max3_f32 v112, v112, v22, v23
    v_max3_f32 v112, v112, v24, v25
    v_max3_f32 v112, v112, v26, v27
    v_max3_f32 v112, v112, v28, v29
    v_max3_f32 v112, v112, v30, v31
    s_nop 7
    s_nop 7
    buffer_load_dwordx4 v[80:83], v108, s[8:11], s33 offen offset:1024
    s_waitcnt vmcnt(0)
    v_mfma_f32_32x32x16_bf16 v[0:15], v[80:83], v[64:67], 0
    v_mfma_f32_32x32x8_bf16 v[0:15], v[86:87], v[72:73], v[0:15]
    v_mfma_f32_32x32x16_bf16 v[16:31], v[80:83], v[68:71], 0
    v_mfma_f32_32x32x8_bf16 v[16:31], v[86:87], v[74:75], v[16:31]
    s_nop 7
    s_nop 7
    v_max3_f32 v110, v110, v0, v1
    v_max3_f32 v110, v110, v2, v3
    v_max3_f32 v110, v110, v4, v5
    v_max3_f32 v110, v110, v6, v7
    v_max3_f32 v110, v110, v8, v9
    v_max3_f32 v110, v110, v10, v11
    v_max3_f32 v110, v110, v12, v13
    v_max3_f32 v110, v110, v14, v15
    v_max3_f32 v112, v112, v16, v17
    v_max3_f32 v112, v112, v18, v19
    v_max3_f32 v112, v112, v20, v21
    v_max3_f32 v112, v112, v22, v23
    v_max3_f32 v112, v112, v24, v25
    v_max3_f32 v112, v112, v26, v27
    v_max3_f32 v112, v112, v28, v29
    v_max3_f32 v112, v112, v30, v31
    s_nop 7
    s_nop 7
    v_add_u32 v108, 5120, v108
    v_add_u32 v109, 5120, v109
    s_add_u32 s28, s28, 1
    s_cmp_lt_u32 s28, 32
    s_cbranch_scc1 L_attn_slow0
    v_mov_b32 v111, v110
    s_nop 1
    v_permlane32_swap_b32 v110, v111
    s_nop 1
    v_max_f32 v110, v110, v111
    v_mov_b32 v111, v112
    s_nop 1
    v_permlane32_swap_b32 v112, v111
    s_nop 1
    v_max_f32 v112, v112, v111
    v_subrev_u32 v108, 163840, v108
    v_subrev_u32 v109, 163840, v109
    v_mov_b32 v32, 0
    v_mov_b32 v33, 0
    v_mov_b32 v34, 0
    v_mov_b32 v35, 0
    v_mov_b32 v36, 0
    v_mov_b32 v37, 0
    v_mov_b32 v38, 0
    v_mov_b32 v39, 0
    v_mov_b32 v40, 0
    v_mov_b32 v41, 0
    v_mov_b32 v42, 0
    v_mov_b32 v43, 0
    v_mov_b32 v44, 0
    v_mov_b32 v45, 0
    v_mov_b32 v46, 0
    v_mov_b32 v47, 0
    v_mov_b32 v48, 0
    v_mov_b32 v49, 0
    v_mov_b32 v50, 0
    v_mov_b32 v51, 0
    v_mov_b32 v52, 0
    v_mov_b32 v53, 0
    v_mov_b32 v54, 0
    v_mov_b32 v55, 0
    v_mov_b32 v56, 0
    v_mov_b32 v57, 0
    v_mov_b32 v58, 0
    v_mov_b32 v59, 0
    v_mov_b32 v60, 0
    v_mov_b32 v61, 0
    v_mov_b32 v62, 0
    v_mov_b32 v63, 0
    s_mov_b32 s28, 0
L_attn_slow1:
    s_mov_b64 exec, s[20:21]
    buffer_load_dwordx4 v[84:87], v108, s[8:11], s33 offen offset:2048
    s_mov_b64 exec, -1
    buffer_load_dwordx4 v[76:79], v108, s[8:11], s33 offen offset:0
    s_mov_b64 exec, s[22:23]
    s_add_u32 s27, s33, 2560
    buffer_load_dwordx4 v[92:95], v109, s[8:11], s27 offen
    buffer_load_dwordx4 v[96:99], v109, s[8:11], s27 offen offset:640
    s_mov_b64 exec, -1
    s_waitcnt vmcnt(0)
    v_mfma_f32_32x32x16_bf16 v[0:15], v[76:79], v[64:67], 0
    v_mfma_f32_32x32x8_bf16 v[0:15], v[84:85], v[72:73], v[0:15]
    v_mfma_f32_32x32x16_bf16 v[16:31], v[76:79], v[68:71], 0
    v_mfma_f32_32x32x8_bf16 v[16:31], v[84:85], v[74:75], v[16:31]
    s_nop 7
    s_nop 7
    v_sub_f32 v0, v0, v110
    v_sub_f32 v1, v1, v110
    v_sub_f32 v2, v2, v110
    v_sub_f32 v3, v3, v110
    v_sub_f32 v4, v4, v110
    v_sub_f32 v5, v5, v110
    v_sub_f32 v6, v6, v110
    v_sub_f32 v7, v7, v110
    v_sub_f32 v8, v8, v110
    v_sub_f32 v9, v9, v110
    v_sub_f32 v10, v10, v110
    v_sub_f32 v11, v11, v110
    v_sub_f32 v12, v12, v110
    v_sub_f32 v13, v13, v110
    v_sub_f32 v14, v14, v110
    v_sub_f32 v15, v15, v110
    v_exp_f32 v0, v0
    v_exp_f32 v1, v1
    v_exp_f32 v2, v2
    v_exp_f32 v3, v3
    v_exp_f32 v4, v4
    v_exp_f32 v5, v5
    v_exp_f32 v6, v6
    v_exp_f32 v7, v7
    v_exp_f32 v8, v8
    v_exp_f32 v9, v9
    v_exp_f32 v10, v10
    v_exp_f32 v11, v11
    v_exp_f32 v12, v12
    v_exp_f32 v13, v13
    v_exp_f32 v14, v14
    v_exp_f32 v15, v15
    s_nop 0
    v_cvt_pk_bf16_f32 v0, v0, v1
    v_cvt_pk_bf16_f32 v1, v2, v3
    v_cvt_pk_bf16_f32 v2, v4, v5
    v_cvt_pk_bf16_f32 v3, v6, v7
    v_cvt_pk_bf16_f32 v8, v8, v9
    v_cvt_pk_bf16_f32 v9, v10, v11
    v_cvt_pk_bf16_f32 v10, v12, v13
    v_cvt_pk_bf16_f32 v11, v14, v15
    s_nop 1
    v_mfma_f32_32x32x16_bf16 v[32:47], v[92:95], v[0:3], v[32:47]
    v_mfma_f32_32x32x16_bf16 v[32:47], v[96:99], v[8:11], v[32:47]
    v_sub_f32 v16, v16, v112
    v_sub_f32 v17, v17, v112
    v_sub_f32 v18, v18, v112
    v_sub_f32 v19, v19, v112
    v_sub_f32 v20, v20, v112
    v_sub_f32 v21, v21, v112
    v_sub_f32 v22, v22, v112
    v_sub_f32 v23, v23, v112
    v_sub_f32 v24, v24, v112
    v_sub_f32 v25, v25, v112
    v_sub_f32 v26, v26, v112
    v_sub_f32 v27, v27, v112
    v_sub_f32 v28, v28, v112
    v_sub_f32 v29, v29, v112
    v_sub_f32 v30, v30, v112
    v_sub_f32 v31, v31, v112
    v_exp_f32 v16, v16
    v_exp_f32 v17, v17
    v_exp_f32 v18, v18
    v_exp_f32 v19, v19
    v_exp_f32 v20, v20
    v_exp_f32 v21, v21
    v_exp_f32 v22, v22
    v_exp_f32 v23, v23
    v_exp_f32 v24, v24
    v_exp_f32 v25, v25
    v_exp_f32 v26, v26
    v_exp_f32 v27, v27
    v_exp_f32 v28, v28
    v_exp_f32 v29, v29
    v_exp_f32 v30, v30
    v_exp_f32 v31, v31
    s_nop 0
    v_cvt_pk_bf16_f32 v16, v16, v17
    v_cvt_pk_bf16_f32 v17, v18, v19
    v_cvt_pk_bf16_f32 v18, v20, v21
    v_cvt_pk_bf16_f32 v19, v22, v23
    v_cvt_pk_bf16_f32 v24, v24, v25
    v_cvt_pk_bf16_f32 v25, v26, v27
    v_cvt_pk_bf16_f32 v26, v28, v29
    v_cvt_pk_bf16_f32 v27, v30, v31
    s_nop 1
    v_mfma_f32_32x32x16_bf16 v[48:63], v[92:95], v[16:19], v[48:63]
    v_mfma_f32_32x32x16_bf16 v[48:63], v[96:99], v[24:27], v[48:63]
    s_nop 7
    s_nop 7
    buffer_load_dwordx4 v[80:83], v108, s[8:11], s33 offen offset:1024
    s_mov_b64 exec, s[22:23]
    s_add_u32 s27, s33, 3840
    buffer_load_dwordx4 v[100:103], v109, s[8:11], s27 offen
    buffer_load_dwordx4 v[104:107], v109, s[8:11], s27 offen offset:640
    s_mov_b64 exec, -1
    s_waitcnt vmcnt(0)
    v_mfma_f32_32x32x16_bf16 v[0:15], v[80:83], v[64:67], 0
    v_mfma_f32_32x32x8_bf16 v[0:15], v[86:87], v[72:73], v[0:15]
    v_mfma_f32_32x32x16_bf16 v[16:31], v[80:83], v[68:71], 0
    v_mfma_f32_32x32x8_bf16 v[16:31], v[86:87], v[74:75], v[16:31]
    s_nop 7
    s_nop 7
    v_sub_f32 v0, v0, v110
    v_sub_f32 v1, v1, v110
    v_sub_f32 v2, v2, v110
    v_sub_f32 v3, v3, v110
    v_sub_f32 v4, v4, v110
    v_sub_f32 v5, v5, v110
    v_sub_f32 v6, v6, v110
    v_sub_f32 v7, v7, v110
    v_sub_f32 v8, v8, v110
    v_sub_f32 v9, v9, v110
    v_sub_f32 v10, v10, v110
    v_sub_f32 v11, v11, v110
    v_sub_f32 v12, v12, v110
    v_sub_f32 v13, v13, v110
    v_sub_f32 v14, v14, v110
    v_sub_f32 v15, v15, v110
    v_exp_f32 v0, v0
    v_exp_f32 v1, v1
    v_exp_f32 v2, v2
    v_exp_f32 v3, v3
    v_exp_f32 v4, v4
    v_exp_f32 v5, v5
    v_exp_f32 v6, v6
    v_exp_f32 v7, v7
    v_exp_f32 v8, v8
    v_exp_f32 v9, v9
    v_exp_f32 v10, v10
    v_exp_f32 v11, v11
    v_exp_f32 v12, v12
    v_exp_f32 v13, v13
    v_exp_f32 v14, v14
    v_exp_f32 v15, v15
    s_nop 0
    v_cvt_pk_bf16_f32 v0, v0, v1
    v_cvt_pk_bf16_f32 v1, v2, v3
    v_cvt_pk_bf16_f32 v2, v4, v5
    v_cvt_pk_bf16_f32 v3, v6, v7
    v_cvt_pk_bf16_f32 v8, v8, v9
    v_cvt_pk_bf16_f32 v9, v10, v11
    v_cvt_pk_bf16_f32 v10, v12, v13
    v_cvt_pk_bf16_f32 v11, v14, v15
    s_nop 1
    v_mfma_f32_32x32x16_bf16 v[32:47], v[100:103], v[0:3], v[32:47]
    v_mfma_f32_32x32x16_bf16 v[32:47], v[104:107], v[8:11], v[32:47]
    v_sub_f32 v16, v16, v112
    v_sub_f32 v17, v17, v112
    v_sub_f32 v18, v18, v112
    v_sub_f32 v19, v19, v112
    v_sub_f32 v20, v20, v112
    v_sub_f32 v21, v21, v112
    v_sub_f32 v22, v22, v112
    v_sub_f32 v23, v23, v112
    v_sub_f32 v24, v24, v112
    v_sub_f32 v25, v25, v112
    v_sub_f32 v26, v26, v112
    v_sub_f32 v27, v27, v112
    v_sub_f32 v28, v28, v112
    v_sub_f32 v29, v29, v112
    v_sub_f32 v30, v30, v112
    v_sub_f32 v31, v31, v112
    v_exp_f32 v16, v16
    v_exp_f32 v17, v17
    v_exp_f32 v18, v18
    v_exp_f32 v19, v19
    v_exp_f32 v20, v20
    v_exp_f32 v21, v21
    v_exp_f32 v22, v22
    v_exp_f32 v23, v23
    v_exp_f32 v24, v24
    v_exp_f32 v25, v25
    v_exp_f32 v26, v26
    v_exp_f32 v27, v27
    v_exp_f32 v28, v28
    v_exp_f32 v29, v29
    v_exp_f32 v30, v30
    v_exp_f32 v31, v31
    s_nop 0
    v_cvt_pk_bf16_f32 v16, v16, v17
    v_cvt_pk_bf16_f32 v17, v18, v19
    v_cvt_pk_bf16_f32 v18, v20, v21
    v_cvt_pk_bf16_f32 v19, v22, v23
    v_cvt_pk_bf16_f32 v24, v24, v25
    v_cvt_pk_bf16_f32 v25, v26, v27
    v_cvt_pk_bf16_f32 v26, v28, v29
    v_cvt_pk_bf16_f32 v27, v30, v31
    s_nop 1
    v_mfma_f32_32x32x16_bf16 v[48:63], v[100:103], v[16:19], v[48:63]
    v_mfma_f32_32x32x16_bf16 v[48:63], v[104:107], v[24:27], v[48:63]
    s_nop 7
    s_nop 7
    v_add_u32 v108, 5120, v108
    v_add_u32 v109, 5120, v109
    s_add_u32 s28, s28, 1
    s_cmp_lt_u32 s28, 32
    s_cbranch_scc1 L_attn_slow1
    s_branch L_attn_epi
L_code_end:
.section .rodata,"a"
.p2align 6
.amdhsa_kernel proj_kernel
  .amdhsa_next_free_vgpr 128
  .amdhsa_next_free_sgpr 96
  .amdhsa_accum_offset 128
  .amdhsa_group_segment_fixed_size 0
  .amdhsa_kernarg_size 96
  .amdhsa_user_sgpr_count 2
  .amdhsa_user_sgpr_kernarg_segment_ptr 1
  .amdhsa_system_sgpr_workgroup_id_x 1
.end_amdhsa_kernel
.p2align 6
.amdhsa_kernel attn_kernel
  .amdhsa_next_free_vgpr 148
  .amdhsa_next_free_sgpr 88
  .amdhsa_accum_offset 148
  .amdhsa_group_segment_fixed_size 0
  .amdhsa_kernarg_size 96
  .amdhsa_user_sgpr_count 2
  .amdhsa_user_sgpr_kernarg_segment_ptr 1
  .amdhsa_system_sgpr_workgroup_id_x 1
.end_amdhsa_kernel
```
